```python
import torch

def _softmax(x, axis=-1):
    return torch.softmax(x, dim=axis)
def _gelu(x):
    return torch.nn.functional.gelu(x, approximate="tanh")
def _silu(x):
    return torch.nn.functional.silu(x)
def _sigmoid(x):
    return torch.sigmoid(x)
def _layernorm(x, axis=-1, eps=1e-5):
    m = x.mean(dim=axis, keepdim=True)
    v = x.var(dim=axis, keepdim=True, unbiased=False)
    return (x - m) / torch.sqrt(v + eps)
def _scatter_add(tgt, idx, src, axis=0):
    return tgt.clone().index_add_(axis, idx, src)
def _segment_sum(src, seg, n):
    out = torch.zeros((n,) + src.shape[1:], dtype=src.dtype)
    return out.index_add_(0, seg, src)
def _pad(x, pw):
    flat = tuple(v for pair in reversed(pw) for v in pair)
    return torch.nn.functional.pad(x, flat)

kernel_name = 'standalone__seq2seq_rnn_t_joint__speech'

def setup_inputs():

    _w = (lambda a: (lambda t: t.to(torch.bfloat16) if t.is_floating_point() else t)(torch.as_tensor(a)))
    B, T, D, K = 2, 4000, 512, 5
    U = 8
    sc = (1.0 / (K * D)) ** 0.5
    sd = (1.0 / D) ** 0.5
    return {
        "x": _w((lambda *s: torch.randn(*s, dtype=torch.bfloat16) * 0.2)(B, T, D) * 0.5),
        "w1": _w((lambda *s: torch.randn(*s, dtype=torch.bfloat16) * 3.2)(K, D, D) * sc),
        "w2": _w((lambda *s: torch.randn(*s, dtype=torch.bfloat16) * 3.2)(K, D, D) * sc),
        "g": _w((lambda *s: torch.randn(*s, dtype=torch.bfloat16) * 3.2)(B, U, D) * 0.5),
        "w_f": _w((lambda *s: torch.randn(*s, dtype=torch.bfloat16) * 3.2)(D, D) * sd),
        "w_g": _w((lambda *s: torch.randn(*s, dtype=torch.bfloat16) * 3.2)(D, D) * sd),
        "w_o": _w((lambda *s: torch.randn(*s, dtype=torch.bfloat16) * 3.2)(D, D) * sd),
    }

def reference(x, w1, w2, g, w_f, w_g, w_o):
    B, T, D = x.shape
    K = w1.shape[0]
    pad = K // 2
    xp = _pad(x, ((0,0),(pad,pad),(0,0)))
    h = torch.zeros_like(x)
    for i in range(K):
        h = h + torch.einsum("btc,cd->btd", xp[:, i:i+T, :], w1[i])
    h = _gelu(h)[:, ::2, :]
    T1 = h.shape[1]
    hp = _pad(h, ((0,0),(pad,pad),(0,0)))
    f = torch.zeros_like(h)
    for i in range(K):
        f = f + torch.einsum("btc,cd->btd", hp[:, i:i+T1, :], w2[i])
    f = _gelu(f)[:, ::2, :]
    fe = torch.einsum("btd,de->bte", f, w_f)
    ge = torch.einsum("bud,de->bue", g, w_g)
    j = torch.tanh(fe[:, :, None, :] + ge[:, None, :, :])
    return torch.einsum("btud,dv->btuv", j, w_o)
```

```asm
; @launch grid=(256,1,1) block=(512,1,1) lds=163840
.amdgcn_target "amdgcn-amd-amdhsa--gfx950"
.text
.set CODE_LAST, L_code_end - L_pc_here - 16
.globl standalone__seq2seq_rnn_t_joint__speech_kernel
.p2align 8
.type standalone__seq2seq_rnn_t_joint__speech_kernel,@function
standalone__seq2seq_rnn_t_joint__speech_kernel:
    s_cmp_ge_u32 s2, 256
    s_cbranch_scc1 L_end
    s_load_dwordx16 s[28:43], s[0:1], 0
    s_load_dwordx4 s[44:47], s[0:1], 64
    s_getpc_b64 s[4:5]
L_pc_here:
    s_lshr_b32 s6, s2, 3
    s_lshl_b32 s6, s6, 3
    v_lshrrev_b32 v1, 6, v0
    v_add_u32 v1, s6, v1
    v_and_b32 v1, 63, v1
    v_lshlrev_b32 v1, 10, v1
    v_and_b32 v2, 63, v0
    v_lshl_add_u32 v1, v2, 4, v1
    v_min_u32 v1, CODE_LAST, v1
    global_load_dwordx4 v[204:207], v1, s[4:5]
    s_and_b32 s48, s2, 7
    s_lshr_b32 s49, s2, 3
    s_lshr_b32 s50, s48, 2
    s_and_b32 s51, s48, 3
    v_lshrrev_b32 v1, 6, v0
    v_and_b32 v0, 63, v0
    s_nop 0
    v_readfirstlane_b32 s54, v1
    s_nop 3
    s_and_b32 s55, s54, 3
    s_lshr_b32 s52, s49, 3
    s_and_b32 s53, s49, 7
    s_waitcnt lgkmcnt(0)
    s_mov_b32 s16, s46
    s_and_b32 s17, s47, 0xffff
    s_mov_b32 s18, 0x10000000
    s_mov_b32 s19, 0x20000
    s_mul_i32 s56, s50, 4096000
    s_add_u32 s8, s28, s56
    s_addc_u32 s9, s29, 0
    s_and_b32 s9, s9, 0xffff
    s_mov_b32 s10, 0x3e8000
    s_mov_b32 s11, 0x20000
    s_mov_b32 s12, s30
    s_and_b32 s13, s31, 0xffff
    s_mov_b32 s14, 0x280000
    s_mov_b32 s15, 0x20000
    s_mov_b32 s20, s42
    s_and_b32 s21, s43, 0xffff
    s_mov_b32 s22, 0xfa0000
    s_mov_b32 s23, 0x20000
    s_cmp_ge_u32 s54, 4
    s_cbranch_scc1 L_Lwaves
    s_cmp_eq_u32 s55, 3
    s_cbranch_scc0 Lo_1
    v_mov_b32 v30, 15925248
    buffer_load_dword v31, v30, s[16:19], 0 offen sc1
Lo_1:
    s_cmp_eq_u32 s55, 1
    s_cbranch_scc0 Lo_2
    v_lshrrev_b32 v2, 3, v0
    v_lshlrev_b32 v2, 19, v2
    v_and_b32 v3, 7, v0
    v_lshl_add_u32 v2, v3, 15, v2
    s_lshl_b32 s56, s49, 10
    s_add_u32 s56, s56, 384
    v_add_u32 v2, s56, v2
    v_cmp_gt_u32 vcc, 40, v0
    v_mov_b32 v3, 0x80000000
    s_nop 0
    v_cndmask_b32 v2, v3, v2, vcc
    buffer_load_dword v208, v2, s[12:15], 0 offen
Lo_2:
    s_cmp_eq_u32 s55, 0
    s_cbranch_scc0 Lo_3
    v_lshlrev_b32 v2, 2, v0
    v_add_u32 v2, 163584, v2
    v_mov_b32 v3, 0
    ds_write_b32 v2, v3
    s_waitcnt lgkmcnt(0)
Lo_3:
    v_and_b32 v2, 15, v0
    v_lshrrev_b32 v3, 4, v0
    s_lshr_b32 s56, s55, 1
    s_lshl_b32 s56, s56, 11
    s_mov_b32 s57, 101376
    s_mov_b32 s59, 0
    v_add_u32 v5, 0, v2
    v_lshlrev_b32 v4, 1, v5
    v_and_b32 v4, 28, v4
    s_mov_b32 s58, 0x42764210
    v_lshrrev_b32 v4, v4, s58
    v_and_b32 v4, 7, v4
    v_xor_b32 v4, v4, v3
    v_xor_b32 v4, s59, v4
    v_lshlrev_b32 v4, 4, v4
    v_lshl_add_u32 v4, v5, 7, v4
    v_add_u32 v12, s56, v4
    v_xor_b32 v14, 64, v12
    v_add_u32 v5, 1, v2
    v_lshlrev_b32 v4, 1, v5
    v_and_b32 v4, 28, v4
    s_mov_b32 s58, 0x42764210
    v_lshrrev_b32 v4, v4, s58
    v_and_b32 v4, 7, v4
    v_xor_b32 v4, v4, v3
    v_xor_b32 v4, s59, v4
    v_lshlrev_b32 v4, 4, v4
    v_lshl_add_u32 v4, v5, 7, v4
    v_add_u32 v13, s56, v4
    v_xor_b32 v15, 64, v13
    v_lshrrev_b32 v4, 2, v2
    v_lshl_add_u32 v5, v3, 3, v4
    v_lshlrev_b32 v5, 7, v5
    v_and_b32 v6, 3, v2
    v_lshl_add_u32 v5, v6, 3, v5
    v_lshrrev_b32 v6, 1, v4
    v_and_b32 v6, 1, v6
    v_and_b32 v7, 1, v3
    v_lshl_or_b32 v6, v7, 1, v6
    s_and_b32 s58, s55, 1
    s_lshl_b32 s58, s58, 1
    v_xor_b32 v6, s58, v6
    v_lshl_add_u32 v7, v6, 5, v5
    v_add_u32 v16, s57, v7
    v_xor_b32 v6, 1, v6
    v_lshl_add_u32 v7, v6, 5, v5
    v_add_u32 v17, s57, v7
    v_mov_b32 v32, 0
    v_mov_b32 v33, 0
    v_mov_b32 v34, 0
    v_mov_b32 v35, 0
    v_mov_b32 v36, 0
    v_mov_b32 v37, 0
    v_mov_b32 v38, 0
    v_mov_b32 v39, 0
    v_mov_b32 v40, 0
    v_mov_b32 v41, 0
    v_mov_b32 v42, 0
    v_mov_b32 v43, 0
    v_mov_b32 v44, 0
    v_mov_b32 v45, 0
    v_mov_b32 v46, 0
    v_mov_b32 v47, 0
    v_mov_b32 v48, 0
    v_mov_b32 v49, 0
    v_mov_b32 v50, 0
    v_mov_b32 v51, 0
    v_mov_b32 v52, 0
    v_mov_b32 v53, 0
    v_mov_b32 v54, 0
    v_mov_b32 v55, 0
    v_mov_b32 v56, 0
    v_mov_b32 v57, 0
    v_mov_b32 v58, 0
    v_mov_b32 v59, 0
    v_mov_b32 v60, 0
    v_mov_b32 v61, 0
    v_mov_b32 v62, 0
    v_mov_b32 v63, 0
    s_mov_b32 s80, 0
    s_mov_b32 s79, 0
    v_mov_b32 v8, v12
    v_mov_b32 v9, v13
    v_mov_b32 v10, v16
    v_mov_b32 v11, v17
    v_and_b32 v2, 15, v0
    v_lshrrev_b32 v3, 4, v0
    s_and_b32 s56, s55, 1
    s_lshl_b32 s56, s56, 3
    v_or_b32 v4, s56, v3
    v_and_b32 v5, 14, v2
    v_xor_b32 v4, v4, v5
    v_lshlrev_b32 v4, 3, v4
    v_lshl_add_u32 v236, v2, 9, v4
    s_lshr_b32 s56, s55, 1
    s_lshl_b32 s56, s56, 13
    v_add_u32 v236, s56, v236
    v_xor_b32 v237, 32, v236
    v_mov_b32 v244, 0xbdd2d3e8
    v_mov_b32 v245, 0xbdd2d3e8
    v_mov_b32 v246, 0xc0135761
    v_mov_b32 v247, 0xc0135761
    v_mov_b32 v248, 1.0
    v_mov_b32 v249, 1.0
    s_lshl_b32 s56, s55, 12
    v_lshl_add_u32 v238, v0, 4, s56
    v_and_b32 v5, 7, v0
    v_lshrrev_b32 v6, 3, v0
    v_lshlrev_b32 v6, 10, v6
    s_and_b32 s58, s55, 1
    s_lshl_b32 s58, s58, 2
    s_add_u32 s58, s58, 0
    v_xor_b32 v7, s58, v5
    v_lshl_add_u32 v7, v7, 4, v6
    v_add_u32 v240, 0, v7
    s_and_b32 s58, s55, 1
    s_lshl_b32 s58, s58, 2
    s_add_u32 s58, s58, 1
    v_xor_b32 v7, s58, v5
    v_lshl_add_u32 v7, v7, 4, v6
    v_add_u32 v241, 8192, v7
    s_and_b32 s58, s55, 1
    s_lshl_b32 s58, s58, 2
    s_add_u32 s58, s58, 2
    v_xor_b32 v7, s58, v5
    v_lshl_add_u32 v7, v7, 4, v6
    v_add_u32 v242, 16384, v7
    s_and_b32 s58, s55, 1
    s_lshl_b32 s58, s58, 2
    s_add_u32 s58, s58, 3
    v_xor_b32 v7, s58, v5
    v_lshl_add_u32 v7, v7, 4, v6
    v_add_u32 v243, 24576, v7
    s_lshl_b32 s73, s48, 19
    s_lshl_b32 s65, s52, 17
    s_add_u32 s73, s73, s65
    s_lshl_b32 s65, s53, 7
    s_add_u32 s73, s73, s65
    s_lshl_b32 s65, s55, 15
    s_add_u32 s73, s73, s65
    s_add_u32 s73, s73, 0
    s_lshl_b32 s76, s48, 9
    s_lshl_b32 s65, s49, 4
    s_add_u32 s76, s76, s65
    s_lshl_b32 s65, s55, 2
    s_add_u32 s76, s76, s65
    s_add_u32 s76, s76, 15933440
    s_barrier
    s_cmp_eq_u32 s55, 3
    s_cbranch_scc0 Lo_4
    s_waitcnt vmcnt(0)
    v_add_u32 v31, 1, v31
    s_nop 0
    v_readfirstlane_b32 s86, v31
    s_getreg_b32 s56, hwreg(HW_REG_XCC_ID, 0, 4)
    s_lshl_b32 s57, s48, 8
    s_lshl_b32 s58, s49, 3
    s_add_u32 s57, s57, s58
    s_add_u32 s57, s57, 15929344
    v_mov_b32 v28, s86
    v_mov_b32 v29, s56
    v_mov_b32 v30, s57
    s_mov_b64 s[70:71], exec
    s_mov_b64 exec, 1
    buffer_store_dwordx2 v[28:29], v30, s[16:19], 0 offen sc1
    s_mov_b64 exec, s[70:71]
    v_mov_b32 v2, 163584
    v_mov_b32 v3, s86
    ds_write_b32 v2, v3
    s_waitcnt lgkmcnt(0)
Lo_4:
    s_cmp_lt_u32 s2, 128
    s_cselect_b32 s56, s55, 0
    s_cmp_eq_u32 s56, 1
    s_cbranch_scc0 Lo_5
    s_mov_b32 s64, s2
    s_lshr_b32 s65, s64, 2
    s_and_b32 s65, s65, 15
    s_and_b32 s66, s64, 3
    s_cmp_ge_u32 s64, 64
    s_cselect_b32 s24, s36, s40
    s_cselect_b32 s25, s37, s41
    s_and_b32 s25, s25, 0xffff
    s_mov_b32 s26, 524288
    s_mov_b32 s27, 0x20000
    v_and_b32 v2, 15, v0
    v_lshrrev_b32 v3, 4, v0
    v_lshlrev_b32 v4, 13, v3
    v_lshl_add_u32 v4, v2, 4, v4
    s_lshl_b32 s67, s65, 15
    s_lshl_b32 s68, s66, 8
    s_add_u32 s67, s67, s68
    v_add_u32 v4, s67, v4
    v_add_u32 v5, 4096, v4
    buffer_load_dwordx4 v[172:175], v4, s[24:27], 0 offen offset:0
    buffer_load_dwordx4 v[176:179], v4, s[24:27], 0 offen offset:1024
    buffer_load_dwordx4 v[180:183], v4, s[24:27], 0 offen offset:2048
    buffer_load_dwordx4 v[184:187], v4, s[24:27], 0 offen offset:3072
    buffer_load_dwordx4 v[188:191], v5, s[24:27], 0 offen offset:0
    buffer_load_dwordx4 v[192:195], v5, s[24:27], 0 offen offset:1024
    buffer_load_dwordx4 v[196:199], v5, s[24:27], 0 offen offset:2048
    buffer_load_dwordx4 v[200:203], v5, s[24:27], 0 offen offset:3072
Lo_5:
    s_cmp_ge_u32 s2, 224
    s_cselect_b32 s56, s55, 0
    s_cmp_eq_u32 s56, 2
    s_cbranch_scc0 Lo_6
    s_mov_b32 s24, s34
    s_and_b32 s25, s35, 0xffff
    s_mov_b32 s26, 0x4000
    s_mov_b32 s27, 0x20000
    v_lshrrev_b32 v4, 2, v0
    v_and_b32 v5, 3, v0
    v_lshlrev_b32 v6, 10, v4
    v_lshl_add_u32 v6, v5, 4, v6
    buffer_load_dwordx4 v[172:175], v6, s[24:27], 0 offen offset:0
    buffer_load_dwordx4 v[176:179], v6, s[24:27], 0 offen offset:64
    buffer_load_dwordx4 v[180:183], v6, s[24:27], 0 offen offset:128
    buffer_load_dwordx4 v[184:187], v6, s[24:27], 0 offen offset:192
    buffer_load_dwordx4 v[188:191], v6, s[24:27], 0 offen offset:256
    buffer_load_dwordx4 v[192:195], v6, s[24:27], 0 offen offset:320
    buffer_load_dwordx4 v[196:199], v6, s[24:27], 0 offen offset:384
    buffer_load_dwordx4 v[200:203], v6, s[24:27], 0 offen offset:448
    buffer_load_dwordx4 v[204:207], v6, s[24:27], 0 offen offset:512
    buffer_load_dwordx4 v[208:211], v6, s[24:27], 0 offen offset:576
    buffer_load_dwordx4 v[212:215], v6, s[24:27], 0 offen offset:640
    buffer_load_dwordx4 v[216:219], v6, s[24:27], 0 offen offset:704
    buffer_load_dwordx4 v[220:223], v6, s[24:27], 0 offen offset:768
    buffer_load_dwordx4 v[224:227], v6, s[24:27], 0 offen offset:832
    buffer_load_dwordx4 v[228:231], v6, s[24:27], 0 offen offset:896
    buffer_load_dwordx4 v[232:235], v6, s[24:27], 0 offen offset:960
Lo_6:
    s_barrier
    ds_read_b64_tr_b16 v[132:133], v10 offset:0
    ds_read_b64_tr_b16 v[134:135], v10 offset:512
    ds_read_b128 v[64:67], v8 offset:0
    ds_read_b64_tr_b16 v[136:137], v11 offset:0
    ds_read_b64_tr_b16 v[138:139], v11 offset:512
    ds_read_b128 v[68:71], v8 offset:4224
    ds_read_b128 v[72:75], v8 offset:8448
    ds_read_b128 v[76:79], v8 offset:12672
    ds_read_b64_tr_b16 v[140:141], v10 offset:4096
    ds_read_b64_tr_b16 v[142:143], v10 offset:4608
    ds_read_b128 v[112:115], v8 offset:16896
    ds_read_b64_tr_b16 v[144:145], v11 offset:4096
    ds_read_b64_tr_b16 v[146:147], v11 offset:4608
    ds_read_b128 v[116:119], v8 offset:21120
    ds_read_b128 v[120:123], v8 offset:25344
    ds_read_b128 v[124:127], v8 offset:29568
    s_mov_b32 s81, 0
L_c1_cloop:
    s_waitcnt lgkmcnt(8)
    v_mfma_f32_16x16x32_bf16 v[32:35], v[132:135], v[64:67], v[32:35]
    ds_read_b64_tr_b16 v[148:149], v10 offset:8192
    v_mfma_f32_16x16x32_bf16 v[36:39], v[136:139], v[64:67], v[36:39]
    ds_read_b64_tr_b16 v[150:151], v10 offset:8704
    v_mfma_f32_16x16x32_bf16 v[40:43], v[132:135], v[68:71], v[40:43]
    ds_read_b128 v[80:83], v9 offset:0
    v_mfma_f32_16x16x32_bf16 v[44:47], v[136:139], v[68:71], v[44:47]
    ds_read_b64_tr_b16 v[152:153], v11 offset:8192
    v_mfma_f32_16x16x32_bf16 v[48:51], v[132:135], v[72:75], v[48:51]
    ds_read_b64_tr_b16 v[154:155], v11 offset:8704
    v_mfma_f32_16x16x32_bf16 v[52:55], v[136:139], v[72:75], v[52:55]
    v_mfma_f32_16x16x32_bf16 v[56:59], v[132:135], v[76:79], v[56:59]
    v_mfma_f32_16x16x32_bf16 v[60:63], v[136:139], v[76:79], v[60:63]
    s_waitcnt lgkmcnt(5)
    v_mfma_f32_16x16x32_bf16 v[32:35], v[140:143], v[112:115], v[32:35]
    ds_read_b64_tr_b16 v[156:157], v10 offset:12288
    v_mfma_f32_16x16x32_bf16 v[36:39], v[144:147], v[112:115], v[36:39]
    ds_read_b64_tr_b16 v[158:159], v10 offset:12800
    v_mfma_f32_16x16x32_bf16 v[40:43], v[140:143], v[116:119], v[40:43]
    ds_read_b128 v[128:131], v9 offset:16896
    v_mfma_f32_16x16x32_bf16 v[44:47], v[144:147], v[116:119], v[44:47]
    ds_read_b64_tr_b16 v[160:161], v11 offset:12288
    v_mfma_f32_16x16x32_bf16 v[48:51], v[140:143], v[120:123], v[48:51]
    ds_read_b64_tr_b16 v[162:163], v11 offset:12800
    v_mfma_f32_16x16x32_bf16 v[52:55], v[144:147], v[120:123], v[52:55]
    s_add_u32 s79, s79, 20480
    s_cmp_ge_u32 s79, 61440
    s_cselect_b32 s79, 0, s79
    v_mfma_f32_16x16x32_bf16 v[56:59], v[140:143], v[124:127], v[56:59]
    v_mfma_f32_16x16x32_bf16 v[60:63], v[144:147], v[124:127], v[60:63]
    s_waitcnt lgkmcnt(5)
    v_mfma_f32_16x16x32_bf16 v[32:35], v[148:151], v[68:71], v[32:35]
    ds_read_b64_tr_b16 v[164:165], v10 offset:16384
    v_mfma_f32_16x16x32_bf16 v[36:39], v[152:155], v[68:71], v[36:39]
    ds_read_b64_tr_b16 v[166:167], v10 offset:16896
    v_mfma_f32_16x16x32_bf16 v[40:43], v[148:151], v[72:75], v[40:43]
    ds_read_b128 v[84:87], v9 offset:4224
    v_mfma_f32_16x16x32_bf16 v[44:47], v[152:155], v[72:75], v[44:47]
    ds_read_b64_tr_b16 v[168:169], v11 offset:16384
    v_mfma_f32_16x16x32_bf16 v[48:51], v[148:151], v[76:79], v[48:51]
    ds_read_b64_tr_b16 v[170:171], v11 offset:16896
    v_mfma_f32_16x16x32_bf16 v[52:55], v[152:155], v[76:79], v[52:55]
    v_add_u32 v18, s79, v16
    v_mfma_f32_16x16x32_bf16 v[56:59], v[148:151], v[80:83], v[56:59]
    v_add_u32 v19, s80, v14
    v_add_u32 v21, s80, v15
    v_mfma_f32_16x16x32_bf16 v[60:63], v[152:155], v[80:83], v[60:63]
    v_add_u32 v20, s79, v17
    s_waitcnt lgkmcnt(0)
    s_barrier
    v_mfma_f32_16x16x32_bf16 v[32:35], v[156:159], v[116:119], v[32:35]
    ds_read_b64_tr_b16 v[132:133], v18 offset:0
    v_mfma_f32_16x16x32_bf16 v[36:39], v[160:163], v[116:119], v[36:39]
    ds_read_b64_tr_b16 v[134:135], v18 offset:512
    v_mfma_f32_16x16x32_bf16 v[40:43], v[156:159], v[120:123], v[40:43]
    ds_read_b128 v[88:91], v19 offset:0
    v_mfma_f32_16x16x32_bf16 v[44:47], v[160:163], v[120:123], v[44:47]
    ds_read_b64_tr_b16 v[136:137], v20 offset:0
    v_mfma_f32_16x16x32_bf16 v[48:51], v[156:159], v[124:127], v[48:51]
    ds_read_b64_tr_b16 v[138:139], v20 offset:512
    v_mfma_f32_16x16x32_bf16 v[52:55], v[160:163], v[124:127], v[52:55]
    ds_read_b128 v[92:95], v19 offset:4224
    v_mfma_f32_16x16x32_bf16 v[56:59], v[156:159], v[128:131], v[56:59]
    ds_read_b128 v[96:99], v19 offset:8448
    v_mfma_f32_16x16x32_bf16 v[60:63], v[160:163], v[128:131], v[60:63]
    ds_read_b128 v[100:103], v19 offset:12672
    v_mfma_f32_16x16x32_bf16 v[32:35], v[164:167], v[72:75], v[32:35]
    ds_read_b64_tr_b16 v[140:141], v18 offset:4096
    v_mfma_f32_16x16x32_bf16 v[36:39], v[168:171], v[72:75], v[36:39]
    ds_read_b64_tr_b16 v[142:143], v18 offset:4608
    v_mfma_f32_16x16x32_bf16 v[40:43], v[164:167], v[76:79], v[40:43]
    ds_read_b128 v[112:115], v19 offset:16896
    v_mfma_f32_16x16x32_bf16 v[44:47], v[168:171], v[76:79], v[44:47]
    ds_read_b64_tr_b16 v[144:145], v20 offset:4096
    v_mfma_f32_16x16x32_bf16 v[48:51], v[164:167], v[80:83], v[48:51]
    ds_read_b64_tr_b16 v[146:147], v20 offset:4608
    v_mfma_f32_16x16x32_bf16 v[52:55], v[168:171], v[80:83], v[52:55]
    ds_read_b128 v[116:119], v19 offset:21120
    v_mfma_f32_16x16x32_bf16 v[56:59], v[164:167], v[84:87], v[56:59]
    ds_read_b128 v[120:123], v19 offset:25344
    v_mfma_f32_16x16x32_bf16 v[60:63], v[168:171], v[84:87], v[60:63]
    ds_read_b128 v[124:127], v19 offset:29568
    s_waitcnt lgkmcnt(8)
    v_mfma_f32_16x16x32_bf16 v[32:35], v[132:135], v[88:91], v[32:35]
    ds_read_b64_tr_b16 v[148:149], v18 offset:8192
    v_mfma_f32_16x16x32_bf16 v[36:39], v[136:139], v[88:91], v[36:39]
    ds_read_b64_tr_b16 v[150:151], v18 offset:8704
    v_mfma_f32_16x16x32_bf16 v[40:43], v[132:135], v[92:95], v[40:43]
    ds_read_b128 v[104:107], v21 offset:0
    v_mfma_f32_16x16x32_bf16 v[44:47], v[136:139], v[92:95], v[44:47]
    ds_read_b64_tr_b16 v[152:153], v20 offset:8192
    v_mfma_f32_16x16x32_bf16 v[48:51], v[132:135], v[96:99], v[48:51]
    ds_read_b64_tr_b16 v[154:155], v20 offset:8704
    v_mfma_f32_16x16x32_bf16 v[52:55], v[136:139], v[96:99], v[52:55]
    v_mfma_f32_16x16x32_bf16 v[56:59], v[132:135], v[100:103], v[56:59]
    v_mfma_f32_16x16x32_bf16 v[60:63], v[136:139], v[100:103], v[60:63]
    s_waitcnt lgkmcnt(5)
    v_mfma_f32_16x16x32_bf16 v[32:35], v[140:143], v[112:115], v[32:35]
    ds_read_b64_tr_b16 v[156:157], v18 offset:12288
    v_mfma_f32_16x16x32_bf16 v[36:39], v[144:147], v[112:115], v[36:39]
    ds_read_b64_tr_b16 v[158:159], v18 offset:12800
    v_mfma_f32_16x16x32_bf16 v[40:43], v[140:143], v[116:119], v[40:43]
    ds_read_b128 v[128:131], v21 offset:16896
    v_mfma_f32_16x16x32_bf16 v[44:47], v[144:147], v[116:119], v[44:47]
    ds_read_b64_tr_b16 v[160:161], v20 offset:12288
    v_mfma_f32_16x16x32_bf16 v[48:51], v[140:143], v[120:123], v[48:51]
    ds_read_b64_tr_b16 v[162:163], v20 offset:12800
    v_mfma_f32_16x16x32_bf16 v[52:55], v[144:147], v[120:123], v[52:55]
    s_add_u32 s79, s79, 20480
    s_cmp_ge_u32 s79, 61440
    s_cselect_b32 s79, 0, s79
    v_mfma_f32_16x16x32_bf16 v[56:59], v[140:143], v[124:127], v[56:59]
    s_add_u32 s80, s80, 33792
    s_cmp_ge_u32 s80, 101376
    s_cselect_b32 s80, 0, s80
    v_mfma_f32_16x16x32_bf16 v[60:63], v[144:147], v[124:127], v[60:63]
    s_waitcnt lgkmcnt(5)
    v_mfma_f32_16x16x32_bf16 v[32:35], v[148:151], v[92:95], v[32:35]
    ds_read_b64_tr_b16 v[164:165], v18 offset:16384
    v_mfma_f32_16x16x32_bf16 v[36:39], v[152:155], v[92:95], v[36:39]
    ds_read_b64_tr_b16 v[166:167], v18 offset:16896
    v_mfma_f32_16x16x32_bf16 v[40:43], v[148:151], v[96:99], v[40:43]
    ds_read_b128 v[108:111], v21 offset:4224
    v_mfma_f32_16x16x32_bf16 v[44:47], v[152:155], v[96:99], v[44:47]
    ds_read_b64_tr_b16 v[168:169], v20 offset:16384
    v_mfma_f32_16x16x32_bf16 v[48:51], v[148:151], v[100:103], v[48:51]
    ds_read_b64_tr_b16 v[170:171], v20 offset:16896
    v_mfma_f32_16x16x32_bf16 v[52:55], v[152:155], v[100:103], v[52:55]
    v_add_u32 v10, s79, v16
    v_mfma_f32_16x16x32_bf16 v[56:59], v[148:151], v[104:107], v[56:59]
    v_add_u32 v8, s80, v12
    v_add_u32 v9, s80, v13
    v_mfma_f32_16x16x32_bf16 v[60:63], v[152:155], v[104:107], v[60:63]
    v_add_u32 v11, s79, v17
    s_waitcnt lgkmcnt(0)
    s_barrier
    v_mfma_f32_16x16x32_bf16 v[32:35], v[156:159], v[116:119], v[32:35]
    ds_read_b64_tr_b16 v[132:133], v10 offset:0
    v_mfma_f32_16x16x32_bf16 v[36:39], v[160:163], v[116:119], v[36:39]
    ds_read_b64_tr_b16 v[134:135], v10 offset:512
    v_mfma_f32_16x16x32_bf16 v[40:43], v[156:159], v[120:123], v[40:43]
    ds_read_b128 v[64:67], v8 offset:0
    v_mfma_f32_16x16x32_bf16 v[44:47], v[160:163], v[120:123], v[44:47]
    ds_read_b64_tr_b16 v[136:137], v11 offset:0
    v_mfma_f32_16x16x32_bf16 v[48:51], v[156:159], v[124:127], v[48:51]
    ds_read_b64_tr_b16 v[138:139], v11 offset:512
    v_mfma_f32_16x16x32_bf16 v[52:55], v[160:163], v[124:127], v[52:55]
    ds_read_b128 v[68:71], v8 offset:4224
    v_mfma_f32_16x16x32_bf16 v[56:59], v[156:159], v[128:131], v[56:59]
    ds_read_b128 v[72:75], v8 offset:8448
    v_mfma_f32_16x16x32_bf16 v[60:63], v[160:163], v[128:131], v[60:63]
    ds_read_b128 v[76:79], v8 offset:12672
    v_mfma_f32_16x16x32_bf16 v[32:35], v[164:167], v[96:99], v[32:35]
    ds_read_b64_tr_b16 v[140:141], v10 offset:4096
    v_mfma_f32_16x16x32_bf16 v[36:39], v[168:171], v[96:99], v[36:39]
    ds_read_b64_tr_b16 v[142:143], v10 offset:4608
    v_mfma_f32_16x16x32_bf16 v[40:43], v[164:167], v[100:103], v[40:43]
    ds_read_b128 v[112:115], v8 offset:16896
    v_mfma_f32_16x16x32_bf16 v[44:47], v[168:171], v[100:103], v[44:47]
    ds_read_b64_tr_b16 v[144:145], v11 offset:4096
    v_mfma_f32_16x16x32_bf16 v[48:51], v[164:167], v[104:107], v[48:51]
    ds_read_b64_tr_b16 v[146:147], v11 offset:4608
    v_mfma_f32_16x16x32_bf16 v[52:55], v[168:171], v[104:107], v[52:55]
    ds_read_b128 v[116:119], v8 offset:21120
    v_mfma_f32_16x16x32_bf16 v[56:59], v[164:167], v[108:111], v[56:59]
    ds_read_b128 v[120:123], v8 offset:25344
    ds_read_b128 v[124:127], v8 offset:29568
    s_add_u32 s81, s81, 2
    s_cmp_lt_u32 s81, 16
    v_mfma_f32_16x16x32_bf16 v[60:63], v[168:171], v[108:111], v[60:63]
    s_cbranch_scc1 L_c1_cloop
    s_waitcnt lgkmcnt(0)
    v_mov_b32 v2, 163584
    ds_read_b64 v[4:5], v2
    s_nop 4
    v_pk_mul_f32 v[64:65], v[32:33], v[32:33]
    v_pk_mul_f32 v[66:67], v[34:35], v[34:35]
    v_pk_mul_f32 v[68:69], v[36:37], v[36:37]
    v_pk_mul_f32 v[70:71], v[38:39], v[38:39]
    v_pk_fma_f32 v[64:65], v[64:65], v[244:245], v[246:247]
    v_pk_fma_f32 v[66:67], v[66:67], v[244:245], v[246:247]
    v_pk_fma_f32 v[68:69], v[68:69], v[244:245], v[246:247]
    v_pk_fma_f32 v[70:71], v[70:71], v[244:245], v[246:247]
    v_pk_mul_f32 v[64:65], v[64:65], v[32:33]
    v_pk_mul_f32 v[66:67], v[66:67], v[34:35]
    v_pk_mul_f32 v[68:69], v[68:69], v[36:37]
    v_pk_mul_f32 v[70:71], v[70:71], v[38:39]
    v_exp_f32 v64, v64
    v_exp_f32 v65, v65
    v_exp_f32 v66, v66
    v_exp_f32 v67, v67
    v_exp_f32 v68, v68
    v_exp_f32 v69, v69
    v_exp_f32 v70, v70
    v_exp_f32 v71, v71
    v_pk_add_f32 v[64:65], v[64:65], v[248:249]
    v_pk_add_f32 v[66:67], v[66:67], v[248:249]
    v_pk_add_f32 v[68:69], v[68:69], v[248:249]
    v_pk_add_f32 v[70:71], v[70:71], v[248:249]
    v_rcp_f32 v64, v64
    v_rcp_f32 v65, v65
    v_rcp_f32 v66, v66
    v_rcp_f32 v67, v67
    v_rcp_f32 v68, v68
    v_rcp_f32 v69, v69
    v_rcp_f32 v70, v70
    v_rcp_f32 v71, v71
    v_pk_mul_f32 v[64:65], v[64:65], v[32:33]
    v_pk_mul_f32 v[66:67], v[66:67], v[34:35]
    v_pk_mul_f32 v[68:69], v[68:69], v[36:37]
    v_pk_mul_f32 v[70:71], v[70:71], v[38:39]
    v_cvt_pk_bf16_f32 v72, v64, v65
    v_cvt_pk_bf16_f32 v73, v66, v67
    v_cvt_pk_bf16_f32 v74, v68, v69
    v_cvt_pk_bf16_f32 v75, v70, v71
    ds_write_b64 v236, v[72:73] offset:0
    ds_write_b64 v237, v[74:75] offset:0
    v_pk_mul_f32 v[64:65], v[40:41], v[40:41]
    v_pk_mul_f32 v[66:67], v[42:43], v[42:43]
    v_pk_mul_f32 v[68:69], v[44:45], v[44:45]
    v_pk_mul_f32 v[70:71], v[46:47], v[46:47]
    v_pk_fma_f32 v[64:65], v[64:65], v[244:245], v[246:247]
    v_pk_fma_f32 v[66:67], v[66:67], v[244:245], v[246:247]
    v_pk_fma_f32 v[68:69], v[68:69], v[244:245], v[246:247]
    v_pk_fma_f32 v[70:71], v[70:71], v[244:245], v[246:247]
    v_pk_mul_f32 v[64:65], v[64:65], v[40:41]
    v_pk_mul_f32 v[66:67], v[66:67], v[42:43]
    v_pk_mul_f32 v[68:69], v[68:69], v[44:45]
    v_pk_mul_f32 v[70:71], v[70:71], v[46:47]
    v_exp_f32 v64, v64
    v_exp_f32 v65, v65
    v_exp_f32 v66, v66
    v_exp_f32 v67, v67
    v_exp_f32 v68, v68
    v_exp_f32 v69, v69
    v_exp_f32 v70, v70
    v_exp_f32 v71, v71
    v_pk_add_f32 v[64:65], v[64:65], v[248:249]
    v_pk_add_f32 v[66:67], v[66:67], v[248:249]
    v_pk_add_f32 v[68:69], v[68:69], v[248:249]
    v_pk_add_f32 v[70:71], v[70:71], v[248:249]
    v_rcp_f32 v64, v64
    v_rcp_f32 v65, v65
    v_rcp_f32 v66, v66
    v_rcp_f32 v67, v67
    v_rcp_f32 v68, v68
    v_rcp_f32 v69, v69
    v_rcp_f32 v70, v70
    v_rcp_f32 v71, v71
    v_pk_mul_f32 v[64:65], v[64:65], v[40:41]
    v_pk_mul_f32 v[66:67], v[66:67], v[42:43]
    v_pk_mul_f32 v[68:69], v[68:69], v[44:45]
    v_pk_mul_f32 v[70:71], v[70:71], v[46:47]
    v_cvt_pk_bf16_f32 v76, v64, v65
    v_cvt_pk_bf16_f32 v77, v66, v67
    v_cvt_pk_bf16_f32 v78, v68, v69
    v_cvt_pk_bf16_f32 v79, v70, v71
    ds_write_b64 v236, v[76:77] offset:128
    ds_write_b64 v237, v[78:79] offset:128
    v_pk_mul_f32 v[64:65], v[48:49], v[48:49]
    v_pk_mul_f32 v[66:67], v[50:51], v[50:51]
    v_pk_mul_f32 v[68:69], v[52:53], v[52:53]
    v_pk_mul_f32 v[70:71], v[54:55], v[54:55]
    v_pk_fma_f32 v[64:65], v[64:65], v[244:245], v[246:247]
    v_pk_fma_f32 v[66:67], v[66:67], v[244:245], v[246:247]
    v_pk_fma_f32 v[68:69], v[68:69], v[244:245], v[246:247]
    v_pk_fma_f32 v[70:71], v[70:71], v[244:245], v[246:247]
    v_pk_mul_f32 v[64:65], v[64:65], v[48:49]
    v_pk_mul_f32 v[66:67], v[66:67], v[50:51]
    v_pk_mul_f32 v[68:69], v[68:69], v[52:53]
    v_pk_mul_f32 v[70:71], v[70:71], v[54:55]
    v_exp_f32 v64, v64
    v_exp_f32 v65, v65
    v_exp_f32 v66, v66
    v_exp_f32 v67, v67
    v_exp_f32 v68, v68
    v_exp_f32 v69, v69
    v_exp_f32 v70, v70
    v_exp_f32 v71, v71
    v_pk_add_f32 v[64:65], v[64:65], v[248:249]
    v_pk_add_f32 v[66:67], v[66:67], v[248:249]
    v_pk_add_f32 v[68:69], v[68:69], v[248:249]
    v_pk_add_f32 v[70:71], v[70:71], v[248:249]
    v_rcp_f32 v64, v64
    v_rcp_f32 v65, v65
    v_rcp_f32 v66, v66
    v_rcp_f32 v67, v67
    v_rcp_f32 v68, v68
    v_rcp_f32 v69, v69
    v_rcp_f32 v70, v70
    v_rcp_f32 v71, v71
    v_pk_mul_f32 v[64:65], v[64:65], v[48:49]
    v_pk_mul_f32 v[66:67], v[66:67], v[50:51]
    v_pk_mul_f32 v[68:69], v[68:69], v[52:53]
    v_pk_mul_f32 v[70:71], v[70:71], v[54:55]
    v_cvt_pk_bf16_f32 v80, v64, v65
    v_cvt_pk_bf16_f32 v81, v66, v67
    v_cvt_pk_bf16_f32 v82, v68, v69
    v_cvt_pk_bf16_f32 v83, v70, v71
    ds_write_b64 v236, v[80:81] offset:256
    ds_write_b64 v237, v[82:83] offset:256
    v_pk_mul_f32 v[64:65], v[56:57], v[56:57]
    v_pk_mul_f32 v[66:67], v[58:59], v[58:59]
    v_pk_mul_f32 v[68:69], v[60:61], v[60:61]
    v_pk_mul_f32 v[70:71], v[62:63], v[62:63]
    v_pk_fma_f32 v[64:65], v[64:65], v[244:245], v[246:247]
    v_pk_fma_f32 v[66:67], v[66:67], v[244:245], v[246:247]
    v_pk_fma_f32 v[68:69], v[68:69], v[244:245], v[246:247]
    v_pk_fma_f32 v[70:71], v[70:71], v[244:245], v[246:247]
    v_pk_mul_f32 v[64:65], v[64:65], v[56:57]
    v_pk_mul_f32 v[66:67], v[66:67], v[58:59]
    v_pk_mul_f32 v[68:69], v[68:69], v[60:61]
    v_pk_mul_f32 v[70:71], v[70:71], v[62:63]
    v_exp_f32 v64, v64
    v_exp_f32 v65, v65
    v_exp_f32 v66, v66
    v_exp_f32 v67, v67
    v_exp_f32 v68, v68
    v_exp_f32 v69, v69
    v_exp_f32 v70, v70
    v_exp_f32 v71, v71
    v_pk_add_f32 v[64:65], v[64:65], v[248:249]
    v_pk_add_f32 v[66:67], v[66:67], v[248:249]
    v_pk_add_f32 v[68:69], v[68:69], v[248:249]
    v_pk_add_f32 v[70:71], v[70:71], v[248:249]
    v_rcp_f32 v64, v64
    v_rcp_f32 v65, v65
    v_rcp_f32 v66, v66
    v_rcp_f32 v67, v67
    v_rcp_f32 v68, v68
    v_rcp_f32 v69, v69
    v_rcp_f32 v70, v70
    v_rcp_f32 v71, v71
    v_pk_mul_f32 v[64:65], v[64:65], v[56:57]
    v_pk_mul_f32 v[66:67], v[66:67], v[58:59]
    v_pk_mul_f32 v[68:69], v[68:69], v[60:61]
    v_pk_mul_f32 v[70:71], v[70:71], v[62:63]
    v_cvt_pk_bf16_f32 v84, v64, v65
    v_cvt_pk_bf16_f32 v85, v66, v67
    v_cvt_pk_bf16_f32 v86, v68, v69
    v_cvt_pk_bf16_f32 v87, v70, v71
    ds_write_b64 v236, v[84:85] offset:384
    ds_write_b64 v237, v[86:87] offset:384
    s_waitcnt lgkmcnt(0)
    s_xor_b32 s68, s55, 1
    s_lshl_b32 s68, s68, 2
    s_add_u32 s68, s68, 163648
    s_lshl_b32 s69, s55, 2
    s_add_u32 s69, s69, 163648
    v_mov_b32 v2, s68
    v_mov_b32 v3, 1
    ds_write_b32 v2, v3
    v_mov_b32 v2, s69
    s_mov_b32 s72, 0
Ly_7:
    ds_read_b32 v3, v2
    s_add_u32 s72, s72, 1
    s_cmp_ge_u32 s72, 320000
    s_cbranch_scc1 Ly_8
    s_waitcnt lgkmcnt(0)
    v_cmp_eq_u32 vcc, 0, v3
    s_cbranch_vccnz Ly_7
Ly_8:
    s_waitcnt lgkmcnt(0)
    v_readfirstlane_b32 s86, v4
    v_readfirstlane_b32 s87, v5
    ds_read_b128 v[24:27], v238 offset:0
    ds_read_b128 v[28:31], v238 offset:1024
    ds_read_b128 v[32:35], v238 offset:2048
    ds_read_b128 v[36:39], v238 offset:3072
    s_waitcnt lgkmcnt(0)
    s_cmp_eq_u32 s87, 0
    s_cbranch_scc1 Ls_9
    buffer_store_dwordx4 v[24:27], v240, s[16:19], s73 offen
    buffer_store_dwordx4 v[28:31], v241, s[16:19], s73 offen
    buffer_store_dwordx4 v[32:35], v242, s[16:19], s73 offen
    buffer_store_dwordx4 v[36:39], v243, s[16:19], s73 offen
    s_branch Ls_10
Ls_9:
    buffer_store_dwordx4 v[24:27], v240, s[16:19], s73 offen sc1
    buffer_store_dwordx4 v[28:31], v241, s[16:19], s73 offen sc1
    buffer_store_dwordx4 v[32:35], v242, s[16:19], s73 offen sc1
    buffer_store_dwordx4 v[36:39], v243, s[16:19], s73 offen sc1
Ls_10:
    s_waitcnt vmcnt(0)
    v_mov_b32 v2, s86
    v_mov_b32 v3, s76
    s_mov_b64 s[70:71], exec
    s_mov_b64 exec, 1
    s_cmp_eq_u32 s87, 0
    s_cbranch_scc1 Lf_11
    buffer_store_dword v2, v3, s[16:19], 0 offen
    s_branch Lf_12
Lf_11:
    buffer_store_dword v2, v3, s[16:19], 0 offen sc1
Lf_12:
    s_mov_b64 exec, s[70:71]
    s_mov_b32 s7, 0
    s_mov_b32 s5, 0
    s_mov_b32 s6, 0
    s_cmp_lt_u32 s2, 128
    s_cselect_b32 s56, s55, 0
    s_cmp_eq_u32 s56, 1
    s_cbranch_scc0 Lo_13
    s_mov_b32 s64, s2
    s_lshr_b32 s65, s64, 2
    s_and_b32 s65, s65, 15
    s_and_b32 s66, s64, 3
    v_and_b32 v2, 15, v0
    v_lshrrev_b32 v3, 4, v0
    s_cmp_ge_u32 s64, 64
    s_cbranch_scc1 Lw_14
    v_and_b32 v6, 7, v2
    v_lshlrev_b32 v5, 6, v6
    v_and_b32 v6, 1, v3
    v_lshl_add_u32 v5, v6, 9, v5
    v_lshrrev_b32 v6, 1, v3
    v_lshl_add_u32 v5, v6, 12, v5
    v_lshrrev_b32 v6, 3, v2
    v_lshl_add_u32 v5, v6, 11, v5
    v_add_u32 v5, 154624, v5
    v_add_u32 v24, 0, v5
    v_add_u32 v25, 1024, v5
    v_add_u32 v26, 16, v5
    v_add_u32 v27, 1040, v5
    v_add_u32 v28, 32, v5
    v_add_u32 v29, 1056, v5
    v_add_u32 v30, 48, v5
    v_add_u32 v31, 1072, v5
    s_lshl_b32 s67, s66, 17
    s_add_u32 s67, s67, 13631488
    s_mul_i32 s68, s65, 6144
    s_add_u32 s68, s68, s67
    s_lshl_b32 s69, s65, 11
    s_add_u32 s69, s69, s67
    s_add_u32 s69, s69, 98304
    s_mov_b32 s70, 0
    s_branch Lw_15
Lw_14:
    v_lshrrev_b32 v5, 1, v2
    v_lshlrev_b32 v5, 10, v5
    v_and_b32 v6, 1, v2
    v_lshl_add_u32 v5, v6, 7, v5
    v_lshl_add_u32 v5, v3, 8, v5
    v_add_u32 v5, 154624, v5
    v_add_u32 v24, 0, v5
    v_add_u32 v25, 16, v5
    v_add_u32 v26, 32, v5
    v_add_u32 v27, 48, v5
    v_add_u32 v28, 64, v5
    v_add_u32 v29, 80, v5
    v_add_u32 v30, 96, v5
    v_add_u32 v31, 112, v5
    s_lshl_b32 s68, s66, 17
    s_lshl_b32 s69, s65, 10
    s_add_u32 s68, s68, s69
    s_add_u32 s68, s68, 14680064
    s_mov_b32 s70, 1
Lw_15:
    s_mov_b32 s65, 0x05040100
    s_mov_b32 s66, 0x07060302
    s_waitcnt vmcnt(1)
    v_perm_b32 v64, v176, v172, s65
    v_perm_b32 v65, v184, v180, s65
    v_perm_b32 v66, v192, v188, s65
    v_perm_b32 v67, v200, v196, s65
    ds_write_b128 v24, v[64:67]
    v_perm_b32 v68, v176, v172, s66
    v_perm_b32 v69, v184, v180, s66
    v_perm_b32 v70, v192, v188, s66
    v_perm_b32 v71, v200, v196, s66
    ds_write_b128 v25, v[68:71]
    v_perm_b32 v72, v177, v173, s65
    v_perm_b32 v73, v185, v181, s65
    v_perm_b32 v74, v193, v189, s65
    v_perm_b32 v75, v201, v197, s65
    ds_write_b128 v26, v[72:75]
    v_perm_b32 v76, v177, v173, s66
    v_perm_b32 v77, v185, v181, s66
    v_perm_b32 v78, v193, v189, s66
    v_perm_b32 v79, v201, v197, s66
    ds_write_b128 v27, v[76:79]
    v_perm_b32 v80, v178, v174, s65
    v_perm_b32 v81, v186, v182, s65
    v_perm_b32 v82, v194, v190, s65
    v_perm_b32 v83, v202, v198, s65
    ds_write_b128 v28, v[80:83]
    v_perm_b32 v84, v178, v174, s66
    v_perm_b32 v85, v186, v182, s66
    v_perm_b32 v86, v194, v190, s66
    v_perm_b32 v87, v202, v198, s66
    ds_write_b128 v29, v[84:87]
    v_perm_b32 v88, v179, v175, s65
    v_perm_b32 v89, v187, v183, s65
    v_perm_b32 v90, v195, v191, s65
    v_perm_b32 v91, v203, v199, s65
    ds_write_b128 v30, v[88:91]
    v_perm_b32 v92, v179, v175, s66
    v_perm_b32 v93, v187, v183, s66
    v_perm_b32 v94, v195, v191, s66
    v_perm_b32 v95, v203, v199, s66
    ds_write_b128 v31, v[92:95]
    v_lshlrev_b32 v2, 4, v0
    v_add_u32 v3, 154624, v2
    s_waitcnt lgkmcnt(0)
    ds_read_b128 v[64:67], v3 offset:0
    ds_read_b128 v[68:71], v3 offset:1024
    ds_read_b128 v[72:75], v3 offset:2048
    ds_read_b128 v[76:79], v3 offset:3072
    ds_read_b128 v[80:83], v3 offset:4096
    ds_read_b128 v[84:87], v3 offset:5120
    ds_read_b128 v[88:91], v3 offset:6144
    ds_read_b128 v[92:95], v3 offset:7168
    s_cmp_eq_u32 s70, 0
    s_cbranch_scc0 Lw_16
    s_add_u32 s65, s68, 0
    s_waitcnt lgkmcnt(7)
    buffer_store_dwordx4 v[64:67], v2, s[16:19], s65 offen sc1
    s_add_u32 s65, s68, 1024
    s_waitcnt lgkmcnt(6)
    buffer_store_dwordx4 v[68:71], v2, s[16:19], s65 offen sc1
    s_add_u32 s65, s68, 2048
    s_waitcnt lgkmcnt(5)
    buffer_store_dwordx4 v[72:75], v2, s[16:19], s65 offen sc1
    s_add_u32 s65, s69, 0
    s_waitcnt lgkmcnt(4)
    buffer_store_dwordx4 v[76:79], v2, s[16:19], s65 offen sc1
    s_add_u32 s65, s68, 3072
    s_waitcnt lgkmcnt(3)
    buffer_store_dwordx4 v[80:83], v2, s[16:19], s65 offen sc1
    s_add_u32 s65, s68, 4096
    s_waitcnt lgkmcnt(2)
    buffer_store_dwordx4 v[84:87], v2, s[16:19], s65 offen sc1
    s_add_u32 s65, s68, 5120
    s_waitcnt lgkmcnt(1)
    buffer_store_dwordx4 v[88:91], v2, s[16:19], s65 offen sc1
    s_add_u32 s65, s69, 1024
    s_waitcnt lgkmcnt(0)
    buffer_store_dwordx4 v[92:95], v2, s[16:19], s65 offen sc1
    s_branch Lw_17
Lw_16:
    s_add_u32 s65, s68, 0
    s_waitcnt lgkmcnt(7)
    buffer_store_dwordx4 v[64:67], v2, s[16:19], s65 offen sc1
    s_add_u32 s65, s68, 16384
    s_waitcnt lgkmcnt(6)
    buffer_store_dwordx4 v[68:71], v2, s[16:19], s65 offen sc1
    s_add_u32 s65, s68, 32768
    s_waitcnt lgkmcnt(5)
    buffer_store_dwordx4 v[72:75], v2, s[16:19], s65 offen sc1
    s_add_u32 s65, s68, 49152
    s_waitcnt lgkmcnt(4)
    buffer_store_dwordx4 v[76:79], v2, s[16:19], s65 offen sc1
    s_add_u32 s65, s68, 65536
    s_waitcnt lgkmcnt(3)
    buffer_store_dwordx4 v[80:83], v2, s[16:19], s65 offen sc1
    s_add_u32 s65, s68, 81920
    s_waitcnt lgkmcnt(2)
    buffer_store_dwordx4 v[84:87], v2, s[16:19], s65 offen sc1
    s_add_u32 s65, s68, 98304
    s_waitcnt lgkmcnt(1)
    buffer_store_dwordx4 v[88:91], v2, s[16:19], s65 offen sc1
    s_add_u32 s65, s68, 114688
    s_waitcnt lgkmcnt(0)
    buffer_store_dwordx4 v[92:95], v2, s[16:19], s65 offen sc1
Lw_17:
    s_lshl_b32 s5, s2, 2
    s_add_u32 s5, s5, 15945728
    s_mov_b32 s7, 1
Lo_13:
    s_cmp_ge_u32 s2, 224
    s_cselect_b32 s56, s55, 0
    s_cmp_eq_u32 s56, 2
    s_cbranch_scc0 Lo_18
    v_and_b32 v4, 15, v0
    v_lshrrev_b32 v5, 4, v0
    v_lshl_add_u32 v4, v4, 2, v5
    v_lshlrev_b32 v4, 2, v4
    ds_bpermute_b32 v172, v4, v172
    ds_bpermute_b32 v173, v4, v173
    ds_bpermute_b32 v174, v4, v174
    ds_bpermute_b32 v175, v4, v175
    ds_bpermute_b32 v176, v4, v176
    ds_bpermute_b32 v177, v4, v177
    ds_bpermute_b32 v178, v4, v178
    ds_bpermute_b32 v179, v4, v179
    s_waitcnt lgkmcnt(0)
    ds_bpermute_b32 v180, v4, v180
    ds_bpermute_b32 v181, v4, v181
    ds_bpermute_b32 v182, v4, v182
    ds_bpermute_b32 v183, v4, v183
    ds_bpermute_b32 v184, v4, v184
    ds_bpermute_b32 v185, v4, v185
    ds_bpermute_b32 v186, v4, v186
    ds_bpermute_b32 v187, v4, v187
    s_waitcnt lgkmcnt(0)
    ds_bpermute_b32 v188, v4, v188
    ds_bpermute_b32 v189, v4, v189
    ds_bpermute_b32 v190, v4, v190
    ds_bpermute_b32 v191, v4, v191
    ds_bpermute_b32 v192, v4, v192
    ds_bpermute_b32 v193, v4, v193
    ds_bpermute_b32 v194, v4, v194
    ds_bpermute_b32 v195, v4, v195
    s_waitcnt lgkmcnt(0)
    ds_bpermute_b32 v196, v4, v196
    ds_bpermute_b32 v197, v4, v197
    ds_bpermute_b32 v198, v4, v198
    ds_bpermute_b32 v199, v4, v199
    ds_bpermute_b32 v200, v4, v200
    ds_bpermute_b32 v201, v4, v201
    ds_bpermute_b32 v202, v4, v202
    ds_bpermute_b32 v203, v4, v203
    s_waitcnt lgkmcnt(0)
    ds_bpermute_b32 v204, v4, v204
    ds_bpermute_b32 v205, v4, v205
    ds_bpermute_b32 v206, v4, v206
    ds_bpermute_b32 v207, v4, v207
    ds_bpermute_b32 v208, v4, v208
    ds_bpermute_b32 v209, v4, v209
    ds_bpermute_b32 v210, v4, v210
    ds_bpermute_b32 v211, v4, v211
    s_waitcnt lgkmcnt(0)
    ds_bpermute_b32 v212, v4, v212
    ds_bpermute_b32 v213, v4, v213
    ds_bpermute_b32 v214, v4, v214
    ds_bpermute_b32 v215, v4, v215
    ds_bpermute_b32 v216, v4, v216
    ds_bpermute_b32 v217, v4, v217
    ds_bpermute_b32 v218, v4, v218
    ds_bpermute_b32 v219, v4, v219
    s_waitcnt lgkmcnt(0)
    ds_bpermute_b32 v220, v4, v220
    ds_bpermute_b32 v221, v4, v221
    ds_bpermute_b32 v222, v4, v222
    ds_bpermute_b32 v223, v4, v223
    ds_bpermute_b32 v224, v4, v224
    ds_bpermute_b32 v225, v4, v225
    ds_bpermute_b32 v226, v4, v226
    ds_bpermute_b32 v227, v4, v227
    s_waitcnt lgkmcnt(0)
    ds_bpermute_b32 v228, v4, v228
    ds_bpermute_b32 v229, v4, v229
    ds_bpermute_b32 v230, v4, v230
    ds_bpermute_b32 v231, v4, v231
    ds_bpermute_b32 v232, v4, v232
    ds_bpermute_b32 v233, v4, v233
    ds_bpermute_b32 v234, v4, v234
    ds_bpermute_b32 v235, v4, v235
    s_waitcnt lgkmcnt(0)
    v_mov_b32 v2, 163696
    s_mov_b32 s72, 0
Lg_19:
    ds_read_b32 v3, v2
    s_add_u32 s72, s72, 1
    s_cmp_ge_u32 s72, 320000
    s_cbranch_scc1 Lg_20
    s_waitcnt lgkmcnt(0)
    v_cmp_eq_u32 vcc, 0, v3
    s_cbranch_vccnz Lg_19
Lg_20:
    s_waitcnt lgkmcnt(0)
    s_sub_u32 s64, s2, 224
    v_and_b32 v4, 15, v0
    v_lshrrev_b32 v5, 4, v0
    v_lshrrev_b32 v7, 2, v4
    v_lshl_add_u32 v7, v5, 3, v7
    v_lshlrev_b32 v7, 5, v7
    v_and_b32 v6, 3, v4
    v_lshl_add_u32 v7, v6, 3, v7
    v_add_u32 v7, 17408, v7
    v_mov_b32 v32, 0
    v_mov_b32 v33, 0
    v_mov_b32 v34, 0
    v_mov_b32 v35, 0
    s_waitcnt vmcnt(0)
    ds_read_b64_tr_b16 v[64:65], v7 offset:0
    ds_read_b64_tr_b16 v[66:67], v7 offset:128
    ds_read_b64_tr_b16 v[68:69], v7 offset:1024
    ds_read_b64_tr_b16 v[70:71], v7 offset:1152
    ds_read_b64_tr_b16 v[72:73], v7 offset:2048
    ds_read_b64_tr_b16 v[74:75], v7 offset:2176
    ds_read_b64_tr_b16 v[76:77], v7 offset:3072
    ds_read_b64_tr_b16 v[78:79], v7 offset:3200
    s_waitcnt lgkmcnt(0)
    ds_read_b64_tr_b16 v[80:81], v7 offset:4096
    ds_read_b64_tr_b16 v[82:83], v7 offset:4224
    ds_read_b64_tr_b16 v[84:85], v7 offset:5120
    ds_read_b64_tr_b16 v[86:87], v7 offset:5248
    ds_read_b64_tr_b16 v[88:89], v7 offset:6144
    ds_read_b64_tr_b16 v[90:91], v7 offset:6272
    ds_read_b64_tr_b16 v[92:93], v7 offset:7168
    ds_read_b64_tr_b16 v[94:95], v7 offset:7296
    s_waitcnt lgkmcnt(0)
    ds_read_b64_tr_b16 v[96:97], v7 offset:8192
    ds_read_b64_tr_b16 v[98:99], v7 offset:8320
    ds_read_b64_tr_b16 v[100:101], v7 offset:9216
    ds_read_b64_tr_b16 v[102:103], v7 offset:9344
    ds_read_b64_tr_b16 v[104:105], v7 offset:10240
    ds_read_b64_tr_b16 v[106:107], v7 offset:10368
    ds_read_b64_tr_b16 v[108:109], v7 offset:11264
    ds_read_b64_tr_b16 v[110:111], v7 offset:11392
    s_waitcnt lgkmcnt(0)
    ds_read_b64_tr_b16 v[112:113], v7 offset:12288
    ds_read_b64_tr_b16 v[114:115], v7 offset:12416
    ds_read_b64_tr_b16 v[116:117], v7 offset:13312
    ds_read_b64_tr_b16 v[118:119], v7 offset:13440
    ds_read_b64_tr_b16 v[120:121], v7 offset:14336
    ds_read_b64_tr_b16 v[122:123], v7 offset:14464
    ds_read_b64_tr_b16 v[124:125], v7 offset:15360
    ds_read_b64_tr_b16 v[126:127], v7 offset:15488
    s_waitcnt lgkmcnt(0)
    v_mfma_f32_16x16x32_bf16 v[32:35], v[64:67], v[172:175], v[32:35]
    v_mfma_f32_16x16x32_bf16 v[32:35], v[68:71], v[176:179], v[32:35]
    v_mfma_f32_16x16x32_bf16 v[32:35], v[72:75], v[180:183], v[32:35]
    v_mfma_f32_16x16x32_bf16 v[32:35], v[76:79], v[184:187], v[32:35]
    v_mfma_f32_16x16x32_bf16 v[32:35], v[80:83], v[188:191], v[32:35]
    v_mfma_f32_16x16x32_bf16 v[32:35], v[84:87], v[192:195], v[32:35]
    v_mfma_f32_16x16x32_bf16 v[32:35], v[88:91], v[196:199], v[32:35]
    v_mfma_f32_16x16x32_bf16 v[32:35], v[92:95], v[200:203], v[32:35]
    v_mfma_f32_16x16x32_bf16 v[32:35], v[96:99], v[204:207], v[32:35]
    v_mfma_f32_16x16x32_bf16 v[32:35], v[100:103], v[208:211], v[32:35]
    v_mfma_f32_16x16x32_bf16 v[32:35], v[104:107], v[212:215], v[32:35]
    v_mfma_f32_16x16x32_bf16 v[32:35], v[108:111], v[216:219], v[32:35]
    v_mfma_f32_16x16x32_bf16 v[32:35], v[112:115], v[220:223], v[32:35]
    v_mfma_f32_16x16x32_bf16 v[32:35], v[116:119], v[224:227], v[32:35]
    v_mfma_f32_16x16x32_bf16 v[32:35], v[120:123], v[228:231], v[32:35]
    v_mfma_f32_16x16x32_bf16 v[32:35], v[124:127], v[232:235], v[32:35]
    s_nop 7
    s_nop 7
    s_mov_b32 s65, 0x4038aa3b
    v_mul_f32 v32, s65, v32
    v_mul_f32 v33, s65, v33
    v_mul_f32 v34, s65, v34
    v_mul_f32 v35, s65, v35
    v_max3_f32 v40, abs(v32), abs(v33), abs(v34)
    v_max_f32 v40, abs(v35), v40
    v_mov_b32 v42, 0x42c00000
    v_cmp_nle_f32 vcc, v40, v42
    v_exp_f32 v36, v32
    v_exp_f32 v37, v33
    v_exp_f32 v38, v34
    v_exp_f32 v39, v35
    s_nop 1
    s_cmp_lg_u64 vcc, 0
    s_cselect_b32 s67, 1, 0
    v_lshrrev_b32 v9, 3, v4
    v_lshlrev_b32 v9, 14, v9
    v_and_b32 v10, 7, v4
    v_lshl_add_u32 v9, v10, 4, v9
    v_lshl_add_u32 v9, v5, 7, v9
    s_lshl_b32 s65, s64, 9
    v_add_u32 v9, s65, v9
    v_add_u32 v10, 15794176, v9
    v_add_u32 v9, 15728640, v9
    buffer_store_dwordx4 v[32:35], v10, s[16:19], 0 offen sc1
    buffer_store_dwordx4 v[36:39], v9, s[16:19], 0 offen sc1
    s_lshl_b32 s5, s64, 3
    s_add_u32 s5, s5, 15949824
    s_mov_b32 s6, s67
    s_mov_b32 s7, 2
Lo_18:
    s_lshr_b32 s84, s55, 1
    s_mul_i32 s84, s84, 20480
    v_and_b32 v2, 15, v0
    v_lshrrev_b32 v3, 4, v0
    s_mov_b32 s56, 0
    s_lshr_b32 s59, s55, 1
    s_mul_i32 s57, s59, 20480
    s_add_u32 s57, s57, 52224
    s_lshl_b32 s59, s59, 2
    v_add_u32 v5, 0, v2
    v_lshlrev_b32 v4, 1, v5
    v_and_b32 v4, 28, v4
    s_mov_b32 s58, 0x42764210
    v_lshrrev_b32 v4, v4, s58
    v_and_b32 v4, 7, v4
    v_xor_b32 v4, v4, v3
    v_xor_b32 v4, s59, v4
    v_lshlrev_b32 v4, 4, v4
    v_lshl_add_u32 v4, v5, 7, v4
    v_add_u32 v12, s56, v4
    v_add_u32 v5, 1, v2
    v_lshlrev_b32 v4, 1, v5
    v_and_b32 v4, 28, v4
    s_mov_b32 s58, 0x42764210
    v_lshrrev_b32 v4, v4, s58
    v_and_b32 v4, 7, v4
    v_xor_b32 v4, v4, v3
    v_xor_b32 v4, s59, v4
    v_lshlrev_b32 v4, 4, v4
    v_lshl_add_u32 v4, v5, 7, v4
    v_add_u32 v13, s56, v4
    v_lshrrev_b32 v4, 2, v2
    v_lshl_add_u32 v5, v3, 3, v4
    v_lshlrev_b32 v5, 7, v5
    v_and_b32 v6, 3, v2
    v_lshl_add_u32 v5, v6, 3, v5
    v_lshrrev_b32 v6, 1, v4
    v_and_b32 v6, 1, v6
    v_and_b32 v7, 1, v3
    v_lshl_or_b32 v6, v7, 1, v6
    s_and_b32 s58, s55, 1
    s_lshl_b32 s58, s58, 1
    v_xor_b32 v6, s58, v6
    v_lshl_add_u32 v7, v6, 5, v5
    v_add_u32 v16, s57, v7
    v_xor_b32 v6, 1, v6
    v_lshl_add_u32 v7, v6, 5, v5
    v_add_u32 v17, s57, v7
    v_mov_b32 v32, 0
    v_mov_b32 v33, 0
    v_mov_b32 v34, 0
    v_mov_b32 v35, 0
    v_mov_b32 v36, 0
    v_mov_b32 v37, 0
    v_mov_b32 v38, 0
    v_mov_b32 v39, 0
    v_mov_b32 v40, 0
    v_mov_b32 v41, 0
    v_mov_b32 v42, 0
    v_mov_b32 v43, 0
    v_mov_b32 v44, 0
    v_mov_b32 v45, 0
    v_mov_b32 v46, 0
    v_mov_b32 v47, 0
    v_mov_b32 v48, 0
    v_mov_b32 v49, 0
    v_mov_b32 v50, 0
    v_mov_b32 v51, 0
    v_mov_b32 v52, 0
    v_mov_b32 v53, 0
    v_mov_b32 v54, 0
    v_mov_b32 v55, 0
    v_mov_b32 v56, 0
    v_mov_b32 v57, 0
    v_mov_b32 v58, 0
    v_mov_b32 v59, 0
    v_mov_b32 v60, 0
    v_mov_b32 v61, 0
    v_mov_b32 v62, 0
    v_mov_b32 v63, 0
    s_mov_b32 s80, 0
    s_mov_b32 s79, 0
    v_mov_b32 v8, v12
    v_mov_b32 v9, v13
    v_mov_b32 v10, v16
    v_mov_b32 v11, v17
    s_lshl_b32 s56, s55, 12
    s_add_u32 s56, s56, 139264
    v_lshl_add_u32 v250, v0, 4, s56
    s_xor_b32 s56, s55, 2
    s_lshl_b32 s56, s56, 12
    s_add_u32 s56, s56, 139264
    v_lshl_add_u32 v251, v0, 4, s56
    v_and_b32 v2, 15, v0
    v_lshrrev_b32 v3, 4, v0
    s_and_b32 s56, s55, 1
    s_lshl_b32 s56, s56, 3
    v_or_b32 v4, s56, v3
    v_and_b32 v5, 14, v2
    v_xor_b32 v4, v4, v5
    v_lshlrev_b32 v4, 3, v4
    v_lshl_add_u32 v236, v2, 9, v4
    v_xor_b32 v237, 32, v236
    v_add_u32 v236, 131072, v236
    v_add_u32 v237, 131072, v237
    v_mov_b32 v244, 0xbdd2d3e8
    v_mov_b32 v245, 0xbdd2d3e8
    v_mov_b32 v246, 0xc0135761
    v_mov_b32 v247, 0xc0135761
    v_mov_b32 v248, 1.0
    v_mov_b32 v249, 1.0
    s_lshr_b32 s56, s55, 1
    s_lshl_b32 s56, s56, 8
    v_add_u32 v236, s56, v236
    v_add_u32 v237, s56, v237
    v_lshrrev_b32 v2, 4, v0
    s_and_b32 s56, s55, 1
    s_lshl_b32 s56, s56, 3
    v_add_u32 v2, s56, v2
    v_bfe_u32 v3, v0, 3, 1
    s_lshr_b32 s57, s55, 1
    s_lshl_b32 s57, s57, 1
    v_add_u32 v3, s57, v3
    v_and_b32 v5, 7, v0
    v_add_u32 v6, 0, v2
    v_lshl_add_u32 v7, v6, 2, v3
    v_lshlrev_b32 v22, 7, v7
    v_lshl_add_u32 v22, v5, 4, v22
    v_add_u32 v238, 131072, v22
    v_bfe_u32 v22, v6, 1, 3
    v_xor_b32 v22, v22, v5
    v_lshlrev_b32 v22, 4, v22
    v_lshl_add_u32 v240, v7, 10, v22
    v_add_u32 v6, 4, v2
    v_lshl_add_u32 v7, v6, 2, v3
    v_lshlrev_b32 v22, 7, v7
    v_lshl_add_u32 v22, v5, 4, v22
    v_add_u32 v239, 131072, v22
    v_bfe_u32 v22, v6, 1, 3
    v_xor_b32 v22, v22, v5
    v_lshlrev_b32 v22, 4, v22
    v_lshl_add_u32 v241, v7, 10, v22
    s_lshl_b32 s73, s48, 18
    s_lshl_b32 s65, s52, 16
    s_add_u32 s73, s73, s65
    s_lshl_b32 s65, s53, 7
    s_add_u32 s73, s73, s65
    s_add_u32 s73, s73, 5242880
    s_lshl_b32 s76, s48, 9
    s_lshl_b32 s65, s49, 4
    s_add_u32 s76, s76, s65
    s_lshl_b32 s65, s55, 2
    s_add_u32 s76, s76, s65
    s_add_u32 s76, s76, 15937536
    s_barrier
    ds_read_b64_tr_b16 v[132:133], v10 offset:0
    ds_read_b64_tr_b16 v[134:135], v10 offset:512
    ds_read_b128 v[64:67], v8 offset:0
    ds_read_b64_tr_b16 v[136:137], v11 offset:0
    ds_read_b64_tr_b16 v[138:139], v11 offset:512
    ds_read_b128 v[68:71], v8 offset:2176
    ds_read_b128 v[72:75], v8 offset:4352
    ds_read_b128 v[76:79], v8 offset:6528
    ds_read_b64_tr_b16 v[140:141], v10 offset:4096
    ds_read_b64_tr_b16 v[142:143], v10 offset:4608
    ds_read_b128 v[112:115], v8 offset:8704
    ds_read_b64_tr_b16 v[144:145], v11 offset:4096
    ds_read_b64_tr_b16 v[146:147], v11 offset:4608
    ds_read_b128 v[116:119], v8 offset:10880
    ds_read_b128 v[120:123], v8 offset:13056
    ds_read_b128 v[124:127], v8 offset:15232
    s_mov_b32 s81, 0
L_c2_cloop:
    s_waitcnt lgkmcnt(8)
    v_mfma_f32_16x16x32_bf16 v[32:35], v[132:135], v[64:67], v[32:35]
    ds_read_b64_tr_b16 v[148:149], v10 offset:8192
    v_mfma_f32_16x16x32_bf16 v[36:39], v[136:139], v[64:67], v[36:39]
    ds_read_b64_tr_b16 v[150:151], v10 offset:8704
    v_mfma_f32_16x16x32_bf16 v[40:43], v[132:135], v[68:71], v[40:43]
    ds_read_b128 v[80:83], v9 offset:0
    v_mfma_f32_16x16x32_bf16 v[44:47], v[136:139], v[68:71], v[44:47]
    ds_read_b64_tr_b16 v[152:153], v11 offset:8192
    v_mfma_f32_16x16x32_bf16 v[48:51], v[132:135], v[72:75], v[48:51]
    ds_read_b64_tr_b16 v[154:155], v11 offset:8704
    v_mfma_f32_16x16x32_bf16 v[52:55], v[136:139], v[72:75], v[52:55]
    v_mfma_f32_16x16x32_bf16 v[56:59], v[132:135], v[76:79], v[56:59]
    v_mfma_f32_16x16x32_bf16 v[60:63], v[136:139], v[76:79], v[60:63]
    s_waitcnt lgkmcnt(5)
    v_mfma_f32_16x16x32_bf16 v[32:35], v[140:143], v[112:115], v[32:35]
    ds_read_b64_tr_b16 v[156:157], v10 offset:12288
    v_mfma_f32_16x16x32_bf16 v[36:39], v[144:147], v[112:115], v[36:39]
    ds_read_b64_tr_b16 v[158:159], v10 offset:12800
    v_mfma_f32_16x16x32_bf16 v[40:43], v[140:143], v[116:119], v[40:43]
    ds_read_b128 v[128:131], v9 offset:8704
    v_mfma_f32_16x16x32_bf16 v[44:47], v[144:147], v[116:119], v[44:47]
    ds_read_b64_tr_b16 v[160:161], v11 offset:12288
    v_mfma_f32_16x16x32_bf16 v[48:51], v[140:143], v[120:123], v[48:51]
    ds_read_b64_tr_b16 v[162:163], v11 offset:12800
    v_mfma_f32_16x16x32_bf16 v[52:55], v[144:147], v[120:123], v[52:55]
    s_add_u32 s79, s79, 40960
    s_add_u32 s56, s79, s84
    s_cmp_ge_u32 s56, 102400
    v_mfma_f32_16x16x32_bf16 v[56:59], v[140:143], v[124:127], v[56:59]
    s_cselect_b32 s56, 102400, 0
    s_sub_u32 s79, s79, s56
    s_add_u32 s80, s80, 34816
    v_mfma_f32_16x16x32_bf16 v[60:63], v[144:147], v[124:127], v[60:63]
    s_cmp_ge_u32 s80, 52224
    s_cselect_b32 s56, 52224, 0
    s_sub_u32 s80, s80, s56
    s_waitcnt lgkmcnt(5)
    v_mfma_f32_16x16x32_bf16 v[32:35], v[148:151], v[68:71], v[32:35]
    ds_read_b64_tr_b16 v[164:165], v10 offset:16384
    v_mfma_f32_16x16x32_bf16 v[36:39], v[152:155], v[68:71], v[36:39]
    ds_read_b64_tr_b16 v[166:167], v10 offset:16896
    v_mfma_f32_16x16x32_bf16 v[40:43], v[148:151], v[72:75], v[40:43]
    ds_read_b128 v[84:87], v9 offset:2176
    v_mfma_f32_16x16x32_bf16 v[44:47], v[152:155], v[72:75], v[44:47]
    ds_read_b64_tr_b16 v[168:169], v11 offset:16384
    v_mfma_f32_16x16x32_bf16 v[48:51], v[148:151], v[76:79], v[48:51]
    ds_read_b64_tr_b16 v[170:171], v11 offset:16896
    v_mfma_f32_16x16x32_bf16 v[52:55], v[152:155], v[76:79], v[52:55]
    v_add_u32 v18, s79, v16
    v_mfma_f32_16x16x32_bf16 v[56:59], v[148:151], v[80:83], v[56:59]
    v_add_u32 v19, s80, v12
    v_add_u32 v21, s80, v13
    v_mfma_f32_16x16x32_bf16 v[60:63], v[152:155], v[80:83], v[60:63]
    v_add_u32 v20, s79, v17
    s_waitcnt lgkmcnt(0)
    s_barrier
    v_mfma_f32_16x16x32_bf16 v[32:35], v[156:159], v[116:119], v[32:35]
    ds_read_b64_tr_b16 v[132:133], v18 offset:0
    v_mfma_f32_16x16x32_bf16 v[36:39], v[160:163], v[116:119], v[36:39]
    ds_read_b64_tr_b16 v[134:135], v18 offset:512
    v_mfma_f32_16x16x32_bf16 v[40:43], v[156:159], v[120:123], v[40:43]
    ds_read_b128 v[88:91], v19 offset:0
    v_mfma_f32_16x16x32_bf16 v[44:47], v[160:163], v[120:123], v[44:47]
    ds_read_b64_tr_b16 v[136:137], v20 offset:0
    v_mfma_f32_16x16x32_bf16 v[48:51], v[156:159], v[124:127], v[48:51]
    ds_read_b64_tr_b16 v[138:139], v20 offset:512
    v_mfma_f32_16x16x32_bf16 v[52:55], v[160:163], v[124:127], v[52:55]
    ds_read_b128 v[92:95], v19 offset:2176
    v_mfma_f32_16x16x32_bf16 v[56:59], v[156:159], v[128:131], v[56:59]
    ds_read_b128 v[96:99], v19 offset:4352
    v_mfma_f32_16x16x32_bf16 v[60:63], v[160:163], v[128:131], v[60:63]
    ds_read_b128 v[100:103], v19 offset:6528
    v_mfma_f32_16x16x32_bf16 v[32:35], v[164:167], v[72:75], v[32:35]
    ds_read_b64_tr_b16 v[140:141], v18 offset:4096
    v_mfma_f32_16x16x32_bf16 v[36:39], v[168:171], v[72:75], v[36:39]
    ds_read_b64_tr_b16 v[142:143], v18 offset:4608
    v_mfma_f32_16x16x32_bf16 v[40:43], v[164:167], v[76:79], v[40:43]
    ds_read_b128 v[112:115], v19 offset:8704
    v_mfma_f32_16x16x32_bf16 v[44:47], v[168:171], v[76:79], v[44:47]
    ds_read_b64_tr_b16 v[144:145], v20 offset:4096
    v_mfma_f32_16x16x32_bf16 v[48:51], v[164:167], v[80:83], v[48:51]
    ds_read_b64_tr_b16 v[146:147], v20 offset:4608
    v_mfma_f32_16x16x32_bf16 v[52:55], v[168:171], v[80:83], v[52:55]
    ds_read_b128 v[116:119], v19 offset:10880
    v_mfma_f32_16x16x32_bf16 v[56:59], v[164:167], v[84:87], v[56:59]
    ds_read_b128 v[120:123], v19 offset:13056
    v_mfma_f32_16x16x32_bf16 v[60:63], v[168:171], v[84:87], v[60:63]
    ds_read_b128 v[124:127], v19 offset:15232
    s_cmp_eq_u32 s81, 0
    s_cbranch_scc0 Le_21
    s_cmp_eq_u32 s7, 0
    s_cbranch_scc1 Ld_22
    v_mov_b32 v22, s86
    v_mov_b32 v23, s6
    v_mov_b32 v24, s5
    s_waitcnt vmcnt(0)
    s_mov_b64 s[70:71], exec
    s_mov_b64 exec, 1
    s_cmp_eq_u32 s7, 1
    s_cbranch_scc1 Ld_23
    buffer_store_dwordx2 v[22:23], v24, s[16:19], 0 offen sc1
    s_branch Ld_23_e
Ld_23:
    buffer_store_dword v22, v24, s[16:19], 0 offen sc1
Ld_23_e:
    s_mov_b64 exec, s[70:71]
    s_mov_b32 s7, 0
Ld_22:
Le_21:
    s_waitcnt lgkmcnt(8)
    v_mfma_f32_16x16x32_bf16 v[32:35], v[132:135], v[88:91], v[32:35]
    ds_read_b64_tr_b16 v[148:149], v18 offset:8192
    v_mfma_f32_16x16x32_bf16 v[36:39], v[136:139], v[88:91], v[36:39]
    ds_read_b64_tr_b16 v[150:151], v18 offset:8704
    v_mfma_f32_16x16x32_bf16 v[40:43], v[132:135], v[92:95], v[40:43]
    ds_read_b128 v[104:107], v21 offset:0
    v_mfma_f32_16x16x32_bf16 v[44:47], v[136:139], v[92:95], v[44:47]
    ds_read_b64_tr_b16 v[152:153], v20 offset:8192
    v_mfma_f32_16x16x32_bf16 v[48:51], v[132:135], v[96:99], v[48:51]
    ds_read_b64_tr_b16 v[154:155], v20 offset:8704
    v_mfma_f32_16x16x32_bf16 v[52:55], v[136:139], v[96:99], v[52:55]
    v_mfma_f32_16x16x32_bf16 v[56:59], v[132:135], v[100:103], v[56:59]
    v_mfma_f32_16x16x32_bf16 v[60:63], v[136:139], v[100:103], v[60:63]
    s_waitcnt lgkmcnt(5)
    v_mfma_f32_16x16x32_bf16 v[32:35], v[140:143], v[112:115], v[32:35]
    ds_read_b64_tr_b16 v[156:157], v18 offset:12288
    v_mfma_f32_16x16x32_bf16 v[36:39], v[144:147], v[112:115], v[36:39]
    ds_read_b64_tr_b16 v[158:159], v18 offset:12800
    v_mfma_f32_16x16x32_bf16 v[40:43], v[140:143], v[116:119], v[40:43]
    ds_read_b128 v[128:131], v21 offset:8704
    v_mfma_f32_16x16x32_bf16 v[44:47], v[144:147], v[116:119], v[44:47]
    ds_read_b64_tr_b16 v[160:161], v20 offset:12288
    v_mfma_f32_16x16x32_bf16 v[48:51], v[140:143], v[120:123], v[48:51]
    ds_read_b64_tr_b16 v[162:163], v20 offset:12800
    v_mfma_f32_16x16x32_bf16 v[52:55], v[144:147], v[120:123], v[52:55]
    s_add_u32 s79, s79, 40960
    s_add_u32 s56, s79, s84
    s_cmp_ge_u32 s56, 102400
    v_mfma_f32_16x16x32_bf16 v[56:59], v[140:143], v[124:127], v[56:59]
    s_cselect_b32 s56, 102400, 0
    s_sub_u32 s79, s79, s56
    s_add_u32 s80, s80, 34816
    v_mfma_f32_16x16x32_bf16 v[60:63], v[144:147], v[124:127], v[60:63]
    s_cmp_ge_u32 s80, 52224
    s_cselect_b32 s56, 52224, 0
    s_sub_u32 s80, s80, s56
    s_waitcnt lgkmcnt(5)
    v_mfma_f32_16x16x32_bf16 v[32:35], v[148:151], v[92:95], v[32:35]
    ds_read_b64_tr_b16 v[164:165], v18 offset:16384
    v_mfma_f32_16x16x32_bf16 v[36:39], v[152:155], v[92:95], v[36:39]
    ds_read_b64_tr_b16 v[166:167], v18 offset:16896
    v_mfma_f32_16x16x32_bf16 v[40:43], v[148:151], v[96:99], v[40:43]
    ds_read_b128 v[108:111], v21 offset:2176
    v_mfma_f32_16x16x32_bf16 v[44:47], v[152:155], v[96:99], v[44:47]
    ds_read_b64_tr_b16 v[168:169], v20 offset:16384
    v_mfma_f32_16x16x32_bf16 v[48:51], v[148:151], v[100:103], v[48:51]
    ds_read_b64_tr_b16 v[170:171], v20 offset:16896
    v_mfma_f32_16x16x32_bf16 v[52:55], v[152:155], v[100:103], v[52:55]
    v_add_u32 v10, s79, v16
    v_mfma_f32_16x16x32_bf16 v[56:59], v[148:151], v[104:107], v[56:59]
    v_add_u32 v8, s80, v12
    v_add_u32 v9, s80, v13
    v_mfma_f32_16x16x32_bf16 v[60:63], v[152:155], v[104:107], v[60:63]
    v_add_u32 v11, s79, v17
    s_waitcnt lgkmcnt(0)
    s_barrier
    v_mfma_f32_16x16x32_bf16 v[32:35], v[156:159], v[116:119], v[32:35]
    ds_read_b64_tr_b16 v[132:133], v10 offset:0
    v_mfma_f32_16x16x32_bf16 v[36:39], v[160:163], v[116:119], v[36:39]
    ds_read_b64_tr_b16 v[134:135], v10 offset:512
    v_mfma_f32_16x16x32_bf16 v[40:43], v[156:159], v[120:123], v[40:43]
    ds_read_b128 v[64:67], v8 offset:0
    v_mfma_f32_16x16x32_bf16 v[44:47], v[160:163], v[120:123], v[44:47]
    ds_read_b64_tr_b16 v[136:137], v11 offset:0
    v_mfma_f32_16x16x32_bf16 v[48:51], v[156:159], v[124:127], v[48:51]
    ds_read_b64_tr_b16 v[138:139], v11 offset:512
    v_mfma_f32_16x16x32_bf16 v[52:55], v[160:163], v[124:127], v[52:55]
    ds_read_b128 v[68:71], v8 offset:2176
    v_mfma_f32_16x16x32_bf16 v[56:59], v[156:159], v[128:131], v[56:59]
    ds_read_b128 v[72:75], v8 offset:4352
    v_mfma_f32_16x16x32_bf16 v[60:63], v[160:163], v[128:131], v[60:63]
    ds_read_b128 v[76:79], v8 offset:6528
    v_mfma_f32_16x16x32_bf16 v[32:35], v[164:167], v[96:99], v[32:35]
    ds_read_b64_tr_b16 v[140:141], v10 offset:4096
    v_mfma_f32_16x16x32_bf16 v[36:39], v[168:171], v[96:99], v[36:39]
    ds_read_b64_tr_b16 v[142:143], v10 offset:4608
    v_mfma_f32_16x16x32_bf16 v[40:43], v[164:167], v[100:103], v[40:43]
    ds_read_b128 v[112:115], v8 offset:8704
    v_mfma_f32_16x16x32_bf16 v[44:47], v[168:171], v[100:103], v[44:47]
    ds_read_b64_tr_b16 v[144:145], v11 offset:4096
    v_mfma_f32_16x16x32_bf16 v[48:51], v[164:167], v[104:107], v[48:51]
    ds_read_b64_tr_b16 v[146:147], v11 offset:4608
    v_mfma_f32_16x16x32_bf16 v[52:55], v[168:171], v[104:107], v[52:55]
    ds_read_b128 v[116:119], v8 offset:10880
    v_mfma_f32_16x16x32_bf16 v[56:59], v[164:167], v[108:111], v[56:59]
    ds_read_b128 v[120:123], v8 offset:13056
    ds_read_b128 v[124:127], v8 offset:15232
    s_add_u32 s81, s81, 2
    s_cmp_lt_u32 s81, 8
    v_mfma_f32_16x16x32_bf16 v[60:63], v[168:171], v[108:111], v[60:63]
    s_cbranch_scc1 L_c2_cloop
    s_waitcnt lgkmcnt(0)
    v_mov_b32 v2, 163592
    ds_read_b32 v4, v2
    s_nop 4
    s_cmp_ge_u32 s55, 2
    s_cbranch_scc1 Lk_24
    ds_write_b128 v250, v[48:51] offset:0
    ds_write_b128 v250, v[52:55] offset:1024
    ds_write_b128 v250, v[56:59] offset:2048
    ds_write_b128 v250, v[60:63] offset:3072
    s_branch Lk_25
Lk_24:
    ds_write_b128 v250, v[32:35] offset:0
    ds_write_b128 v250, v[36:39] offset:1024
    ds_write_b128 v250, v[40:43] offset:2048
    ds_write_b128 v250, v[44:47] offset:3072
    s_waitcnt lgkmcnt(0)
    v_mov_b32 v32, v48
    v_mov_b32 v33, v49
    v_mov_b32 v34, v50
    v_mov_b32 v35, v51
    v_mov_b32 v36, v52
    v_mov_b32 v37, v53
    v_mov_b32 v38, v54
    v_mov_b32 v39, v55
    v_mov_b32 v40, v56
    v_mov_b32 v41, v57
    v_mov_b32 v42, v58
    v_mov_b32 v43, v59
    v_mov_b32 v44, v60
    v_mov_b32 v45, v61
    v_mov_b32 v46, v62
    v_mov_b32 v47, v63
Lk_25:
    s_waitcnt lgkmcnt(0)
    s_xor_b32 s68, s55, 2
    s_lshl_b32 s68, s68, 2
    s_add_u32 s68, s68, 163664
    s_lshl_b32 s69, s55, 2
    s_add_u32 s69, s69, 163664
    v_mov_b32 v2, s68
    v_mov_b32 v3, 1
    ds_write_b32 v2, v3
    v_mov_b32 v2, s69
    s_mov_b32 s72, 0
Ly_26:
    ds_read_b32 v3, v2
    s_add_u32 s72, s72, 1
    s_cmp_ge_u32 s72, 320000
    s_cbranch_scc1 Ly_27
    s_waitcnt lgkmcnt(0)
    v_cmp_eq_u32 vcc, 0, v3
    s_cbranch_vccnz Ly_26
Ly_27:
    s_waitcnt lgkmcnt(0)
    v_readfirstlane_b32 s85, v4
    ds_read_b128 v[64:67], v251 offset:0
    ds_read_b128 v[68:71], v251 offset:1024
    ds_read_b128 v[72:75], v251 offset:2048
    ds_read_b128 v[76:79], v251 offset:3072
    s_waitcnt lgkmcnt(3)
    v_pk_add_f32 v[32:33], v[32:33], v[64:65]
    v_pk_add_f32 v[34:35], v[34:35], v[66:67]
    s_waitcnt lgkmcnt(2)
    v_pk_add_f32 v[36:37], v[36:37], v[68:69]
    v_pk_add_f32 v[38:39], v[38:39], v[70:71]
    s_waitcnt lgkmcnt(1)
    v_pk_add_f32 v[40:41], v[40:41], v[72:73]
    v_pk_add_f32 v[42:43], v[42:43], v[74:75]
    s_waitcnt lgkmcnt(0)
    v_pk_add_f32 v[44:45], v[44:45], v[76:77]
    v_pk_add_f32 v[46:47], v[46:47], v[78:79]
    v_pk_mul_f32 v[80:81], v[32:33], v[32:33]
    v_pk_mul_f32 v[82:83], v[34:35], v[34:35]
    v_pk_mul_f32 v[84:85], v[36:37], v[36:37]
    v_pk_mul_f32 v[86:87], v[38:39], v[38:39]
    v_pk_fma_f32 v[80:81], v[80:81], v[244:245], v[246:247]
    v_pk_fma_f32 v[82:83], v[82:83], v[244:245], v[246:247]
    v_pk_fma_f32 v[84:85], v[84:85], v[244:245], v[246:247]
    v_pk_fma_f32 v[86:87], v[86:87], v[244:245], v[246:247]
    v_pk_mul_f32 v[80:81], v[80:81], v[32:33]
    v_pk_mul_f32 v[82:83], v[82:83], v[34:35]
    v_pk_mul_f32 v[84:85], v[84:85], v[36:37]
    v_pk_mul_f32 v[86:87], v[86:87], v[38:39]
    v_exp_f32 v80, v80
    v_exp_f32 v81, v81
    v_exp_f32 v82, v82
    v_exp_f32 v83, v83
    v_exp_f32 v84, v84
    v_exp_f32 v85, v85
    v_exp_f32 v86, v86
    v_exp_f32 v87, v87
    v_pk_add_f32 v[80:81], v[80:81], v[248:249]
    v_pk_add_f32 v[82:83], v[82:83], v[248:249]
    v_pk_add_f32 v[84:85], v[84:85], v[248:249]
    v_pk_add_f32 v[86:87], v[86:87], v[248:249]
    v_rcp_f32 v80, v80
    v_rcp_f32 v81, v81
    v_rcp_f32 v82, v82
    v_rcp_f32 v83, v83
    v_rcp_f32 v84, v84
    v_rcp_f32 v85, v85
    v_rcp_f32 v86, v86
    v_rcp_f32 v87, v87
    v_pk_mul_f32 v[80:81], v[80:81], v[32:33]
    v_pk_mul_f32 v[82:83], v[82:83], v[34:35]
    v_pk_mul_f32 v[84:85], v[84:85], v[36:37]
    v_pk_mul_f32 v[86:87], v[86:87], v[38:39]
    v_cvt_pk_bf16_f32 v72, v80, v81
    v_cvt_pk_bf16_f32 v73, v82, v83
    v_cvt_pk_bf16_f32 v74, v84, v85
    v_cvt_pk_bf16_f32 v75, v86, v87
    ds_write_b64 v236, v[72:73] offset:0
    ds_write_b64 v237, v[74:75] offset:0
    v_pk_mul_f32 v[80:81], v[40:41], v[40:41]
    v_pk_mul_f32 v[82:83], v[42:43], v[42:43]
    v_pk_mul_f32 v[84:85], v[44:45], v[44:45]
    v_pk_mul_f32 v[86:87], v[46:47], v[46:47]
    v_pk_fma_f32 v[80:81], v[80:81], v[244:245], v[246:247]
    v_pk_fma_f32 v[82:83], v[82:83], v[244:245], v[246:247]
    v_pk_fma_f32 v[84:85], v[84:85], v[244:245], v[246:247]
    v_pk_fma_f32 v[86:87], v[86:87], v[244:245], v[246:247]
    v_pk_mul_f32 v[80:81], v[80:81], v[40:41]
    v_pk_mul_f32 v[82:83], v[82:83], v[42:43]
    v_pk_mul_f32 v[84:85], v[84:85], v[44:45]
    v_pk_mul_f32 v[86:87], v[86:87], v[46:47]
    v_exp_f32 v80, v80
    v_exp_f32 v81, v81
    v_exp_f32 v82, v82
    v_exp_f32 v83, v83
    v_exp_f32 v84, v84
    v_exp_f32 v85, v85
    v_exp_f32 v86, v86
    v_exp_f32 v87, v87
    v_pk_add_f32 v[80:81], v[80:81], v[248:249]
    v_pk_add_f32 v[82:83], v[82:83], v[248:249]
    v_pk_add_f32 v[84:85], v[84:85], v[248:249]
    v_pk_add_f32 v[86:87], v[86:87], v[248:249]
    v_rcp_f32 v80, v80
    v_rcp_f32 v81, v81
    v_rcp_f32 v82, v82
    v_rcp_f32 v83, v83
    v_rcp_f32 v84, v84
    v_rcp_f32 v85, v85
    v_rcp_f32 v86, v86
    v_rcp_f32 v87, v87
    v_pk_mul_f32 v[80:81], v[80:81], v[40:41]
    v_pk_mul_f32 v[82:83], v[82:83], v[42:43]
    v_pk_mul_f32 v[84:85], v[84:85], v[44:45]
    v_pk_mul_f32 v[86:87], v[86:87], v[46:47]
    v_cvt_pk_bf16_f32 v76, v80, v81
    v_cvt_pk_bf16_f32 v77, v82, v83
    v_cvt_pk_bf16_f32 v78, v84, v85
    v_cvt_pk_bf16_f32 v79, v86, v87
    ds_write_b64 v236, v[76:77] offset:128
    ds_write_b64 v237, v[78:79] offset:128
    s_waitcnt lgkmcnt(0)
    s_xor_b32 s68, s55, 1
    s_lshl_b32 s68, s68, 2
    s_add_u32 s68, s68, 163680
    s_lshl_b32 s69, s55, 2
    s_add_u32 s69, s69, 163680
    v_mov_b32 v2, s68
    v_mov_b32 v3, 1
    ds_write_b32 v2, v3
    v_mov_b32 v2, s69
    s_mov_b32 s72, 0
Ly_28:
    ds_read_b32 v3, v2
    s_add_u32 s72, s72, 1
    s_cmp_ge_u32 s72, 320000
    s_cbranch_scc1 Ly_29
    s_waitcnt lgkmcnt(0)
    v_cmp_eq_u32 vcc, 0, v3
    s_cbranch_vccnz Ly_28
Ly_29:
    s_waitcnt lgkmcnt(0)
    ds_read_b128 v[24:27], v238
    ds_read_b128 v[28:31], v239
    s_waitcnt lgkmcnt(0)
    s_cmp_eq_u32 s87, 0
    s_cbranch_scc1 Ls_30
    buffer_store_dwordx4 v[24:27], v240, s[16:19], s73 offen
    buffer_store_dwordx4 v[28:31], v241, s[16:19], s73 offen
    s_branch Ls_31
Ls_30:
    buffer_store_dwordx4 v[24:27], v240, s[16:19], s73 offen sc1
    buffer_store_dwordx4 v[28:31], v241, s[16:19], s73 offen sc1
Ls_31:
    s_waitcnt vmcnt(0)
    v_mov_b32 v2, s86
    v_mov_b32 v3, s76
    s_mov_b64 s[70:71], exec
    s_mov_b64 exec, 1
    s_cmp_eq_u32 s87, 0
    s_cbranch_scc1 Lf_32
    buffer_store_dword v2, v3, s[16:19], 0 offen
    s_branch Lf_33
Lf_32:
    buffer_store_dword v2, v3, s[16:19], 0 offen sc1
Lf_33:
    s_mov_b64 exec, s[70:71]
    v_and_b32 v2, 15, v0
    v_lshrrev_b32 v3, 4, v0
    v_lshlrev_b32 v4, 1, v2
    v_and_b32 v4, 28, v4
    s_mov_b32 s58, 0x42764210
    v_lshrrev_b32 v4, v4, s58
    v_and_b32 v4, 7, v4
    v_xor_b32 v4, v4, v3
    v_lshlrev_b32 v4, 4, v4
    v_lshl_add_u32 v8, v2, 7, v4
    v_add_u32 v8, 131072, v8
    v_xor_b32 v9, 64, v8
    s_lshl_b32 s56, s55, 15
    v_lshl_add_u32 v10, v0, 4, s56
    v_mov_b32 v32, 0
    v_mov_b32 v33, 0
    v_mov_b32 v34, 0
    v_mov_b32 v35, 0
    v_mov_b32 v36, 0
    v_mov_b32 v37, 0
    v_mov_b32 v38, 0
    v_mov_b32 v39, 0
    v_mov_b32 v40, 0
    v_mov_b32 v41, 0
    v_mov_b32 v42, 0
    v_mov_b32 v43, 0
    v_mov_b32 v44, 0
    v_mov_b32 v45, 0
    v_mov_b32 v46, 0
    v_mov_b32 v47, 0
    v_lshlrev_b32 v4, 11, v2
    v_lshl_add_u32 v240, v3, 4, v4
    v_add_u32 v241, 0x8000, v240
    s_lshr_b32 s56, s49, 2
    s_lshl_b32 s56, s56, 16
    s_and_b32 s57, s49, 3
    s_lshl_b32 s57, s57, 9
    s_add_u32 s56, s56, s57
    s_lshl_b32 s57, s55, 7
    s_add_u32 s56, s56, s57
    s_lshl_b32 s57, s48, 19
    s_add_u32 s56, s56, s57
    s_add_u32 s73, s56, 8388608
    v_mov_b32 v6, 0x42fc0000
    v_mov_b32 v7, 0xc2fc0000
    s_lshl_b32 s76, s48, 9
    s_lshl_b32 s65, s49, 4
    s_add_u32 s76, s76, s65
    s_lshl_b32 s65, s55, 2
    s_add_u32 s76, s76, s65
    s_add_u32 s76, s76, 15941632
    s_barrier
    ds_read_b128 v[128:131], v10 offset:0
    ds_read_b128 v[132:135], v10 offset:16384
    ds_read_b128 v[136:139], v10 offset:1024
    ds_read_b128 v[140:143], v10 offset:17408
    ds_read_b128 v[144:147], v10 offset:2048
    ds_read_b128 v[148:151], v10 offset:18432
    ds_read_b128 v[152:155], v10 offset:3072
    ds_read_b128 v[156:159], v10 offset:19456
    s_waitcnt lgkmcnt(0)
    ds_read_b128 v[160:163], v10 offset:4096
    ds_read_b128 v[164:167], v10 offset:20480
    ds_read_b128 v[168:171], v10 offset:5120
    ds_read_b128 v[172:175], v10 offset:21504
    ds_read_b128 v[176:179], v10 offset:6144
    ds_read_b128 v[180:183], v10 offset:22528
    ds_read_b128 v[184:187], v10 offset:7168
    ds_read_b128 v[188:191], v10 offset:23552
    s_waitcnt lgkmcnt(0)
    ds_read_b128 v[192:195], v10 offset:8192
    ds_read_b128 v[196:199], v10 offset:24576
    ds_read_b128 v[200:203], v10 offset:9216
    ds_read_b128 v[204:207], v10 offset:25600
    ds_read_b128 v[208:211], v10 offset:10240
    ds_read_b128 v[212:215], v10 offset:26624
    ds_read_b128 v[216:219], v10 offset:11264
    ds_read_b128 v[220:223], v10 offset:27648
    s_waitcnt lgkmcnt(0)
    s_barrier
    ds_read_b128 v[64:67], v8 offset:0
    ds_read_b128 v[68:71], v8 offset:2048
    ds_read_b128 v[80:83], v9 offset:0
    ds_read_b128 v[84:87], v9 offset:2048
    ds_read_b128 v[96:99], v8 offset:4096
    ds_read_b128 v[100:103], v8 offset:6144
    s_waitcnt lgkmcnt(4)
    v_mfma_f32_16x16x32_bf16 v[32:35], v[128:131], v[64:67], v[32:35]
    ds_read_b128 v[112:115], v9 offset:4096
    v_mfma_f32_16x16x32_bf16 v[36:39], v[132:135], v[64:67], v[36:39]
    ds_read_b128 v[116:119], v9 offset:6144
    v_mfma_f32_16x16x32_bf16 v[40:43], v[128:131], v[68:71], v[40:43]
    v_mfma_f32_16x16x32_bf16 v[44:47], v[132:135], v[68:71], v[44:47]
    s_waitcnt lgkmcnt(4)
    v_mfma_f32_16x16x32_bf16 v[32:35], v[136:139], v[80:83], v[32:35]
    v_mfma_f32_16x16x32_bf16 v[36:39], v[140:143], v[80:83], v[36:39]
    v_mfma_f32_16x16x32_bf16 v[40:43], v[136:139], v[84:87], v[40:43]
    v_mfma_f32_16x16x32_bf16 v[44:47], v[140:143], v[84:87], v[44:47]
    s_waitcnt lgkmcnt(2)
    v_mfma_f32_16x16x32_bf16 v[32:35], v[144:147], v[96:99], v[32:35]
    v_mfma_f32_16x16x32_bf16 v[36:39], v[148:151], v[96:99], v[36:39]
    v_mfma_f32_16x16x32_bf16 v[40:43], v[144:147], v[100:103], v[40:43]
    v_mfma_f32_16x16x32_bf16 v[44:47], v[148:151], v[100:103], v[44:47]
    s_waitcnt lgkmcnt(0)
    v_mfma_f32_16x16x32_bf16 v[32:35], v[152:155], v[112:115], v[32:35]
    v_mfma_f32_16x16x32_bf16 v[36:39], v[156:159], v[112:115], v[36:39]
    v_mfma_f32_16x16x32_bf16 v[40:43], v[152:155], v[116:119], v[40:43]
    v_mfma_f32_16x16x32_bf16 v[44:47], v[156:159], v[116:119], v[44:47]
    s_barrier
    ds_read_b128 v[64:67], v8 offset:8192
    ds_read_b128 v[68:71], v8 offset:10240
    ds_read_b128 v[80:83], v9 offset:8192
    ds_read_b128 v[84:87], v9 offset:10240
    ds_read_b128 v[96:99], v8 offset:12288
    ds_read_b128 v[100:103], v8 offset:14336
    s_waitcnt lgkmcnt(4)
    v_mfma_f32_16x16x32_bf16 v[32:35], v[160:163], v[64:67], v[32:35]
    ds_read_b128 v[112:115], v9 offset:12288
    v_mfma_f32_16x16x32_bf16 v[36:39], v[164:167], v[64:67], v[36:39]
    ds_read_b128 v[116:119], v9 offset:14336
    v_mfma_f32_16x16x32_bf16 v[40:43], v[160:163], v[68:71], v[40:43]
    v_mfma_f32_16x16x32_bf16 v[44:47], v[164:167], v[68:71], v[44:47]
    s_waitcnt lgkmcnt(4)
    v_mfma_f32_16x16x32_bf16 v[32:35], v[168:171], v[80:83], v[32:35]
    v_mfma_f32_16x16x32_bf16 v[36:39], v[172:175], v[80:83], v[36:39]
    v_mfma_f32_16x16x32_bf16 v[40:43], v[168:171], v[84:87], v[40:43]
    v_mfma_f32_16x16x32_bf16 v[44:47], v[172:175], v[84:87], v[44:47]
    s_waitcnt lgkmcnt(2)
    v_mfma_f32_16x16x32_bf16 v[32:35], v[176:179], v[96:99], v[32:35]
    v_mfma_f32_16x16x32_bf16 v[36:39], v[180:183], v[96:99], v[36:39]
    v_mfma_f32_16x16x32_bf16 v[40:43], v[176:179], v[100:103], v[40:43]
    v_mfma_f32_16x16x32_bf16 v[44:47], v[180:183], v[100:103], v[44:47]
    s_waitcnt lgkmcnt(0)
    v_mfma_f32_16x16x32_bf16 v[32:35], v[184:187], v[112:115], v[32:35]
    v_mfma_f32_16x16x32_bf16 v[36:39], v[188:191], v[112:115], v[36:39]
    v_mfma_f32_16x16x32_bf16 v[40:43], v[184:187], v[116:119], v[40:43]
    v_mfma_f32_16x16x32_bf16 v[44:47], v[188:191], v[116:119], v[44:47]
    s_barrier
    ds_read_b128 v[64:67], v8 offset:16384
    ds_read_b128 v[68:71], v8 offset:18432
    ds_read_b128 v[80:83], v9 offset:16384
    ds_read_b128 v[84:87], v9 offset:18432
    ds_read_b128 v[96:99], v8 offset:20480
    ds_read_b128 v[100:103], v8 offset:22528
    s_waitcnt lgkmcnt(4)
    v_mfma_f32_16x16x32_bf16 v[32:35], v[192:195], v[64:67], v[32:35]
    ds_read_b128 v[112:115], v9 offset:20480
    v_mfma_f32_16x16x32_bf16 v[36:39], v[196:199], v[64:67], v[36:39]
    ds_read_b128 v[116:119], v9 offset:22528
    v_mfma_f32_16x16x32_bf16 v[40:43], v[192:195], v[68:71], v[40:43]
    v_mfma_f32_16x16x32_bf16 v[44:47], v[196:199], v[68:71], v[44:47]
    s_waitcnt lgkmcnt(4)
    v_mfma_f32_16x16x32_bf16 v[32:35], v[200:203], v[80:83], v[32:35]
    v_mfma_f32_16x16x32_bf16 v[36:39], v[204:207], v[80:83], v[36:39]
    v_mfma_f32_16x16x32_bf16 v[40:43], v[200:203], v[84:87], v[40:43]
    v_mfma_f32_16x16x32_bf16 v[44:47], v[204:207], v[84:87], v[44:47]
    s_waitcnt lgkmcnt(2)
    v_mfma_f32_16x16x32_bf16 v[32:35], v[208:211], v[96:99], v[32:35]
    v_mfma_f32_16x16x32_bf16 v[36:39], v[212:215], v[96:99], v[36:39]
    v_mfma_f32_16x16x32_bf16 v[40:43], v[208:211], v[100:103], v[40:43]
    v_mfma_f32_16x16x32_bf16 v[44:47], v[212:215], v[100:103], v[44:47]
    s_waitcnt lgkmcnt(0)
    v_mfma_f32_16x16x32_bf16 v[32:35], v[216:219], v[112:115], v[32:35]
    v_mfma_f32_16x16x32_bf16 v[36:39], v[220:223], v[112:115], v[36:39]
    v_mfma_f32_16x16x32_bf16 v[40:43], v[216:219], v[116:119], v[40:43]
    v_mfma_f32_16x16x32_bf16 v[44:47], v[220:223], v[116:119], v[44:47]
    s_barrier
    ds_read_b128 v[72:75], v10 offset:12288
    ds_read_b128 v[76:79], v10 offset:28672
    ds_read_b128 v[64:67], v8 offset:24576
    ds_read_b128 v[68:71], v8 offset:26624
    ds_read_b128 v[88:91], v10 offset:13312
    ds_read_b128 v[92:95], v10 offset:29696
    ds_read_b128 v[80:83], v9 offset:24576
    ds_read_b128 v[84:87], v9 offset:26624
    ds_read_b128 v[104:107], v10 offset:14336
    ds_read_b128 v[108:111], v10 offset:30720
    ds_read_b128 v[96:99], v8 offset:28672
    ds_read_b128 v[100:103], v8 offset:30720
    s_waitcnt lgkmcnt(8)
    v_mfma_f32_16x16x32_bf16 v[32:35], v[72:75], v[64:67], v[32:35]
    ds_read_b128 v[120:123], v10 offset:15360
    v_mfma_f32_16x16x32_bf16 v[36:39], v[76:79], v[64:67], v[36:39]
    ds_read_b128 v[124:127], v10 offset:31744
    v_mfma_f32_16x16x32_bf16 v[40:43], v[72:75], v[68:71], v[40:43]
    ds_read_b128 v[112:115], v9 offset:28672
    v_mfma_f32_16x16x32_bf16 v[44:47], v[76:79], v[68:71], v[44:47]
    ds_read_b128 v[116:119], v9 offset:30720
    s_waitcnt lgkmcnt(8)
    v_mfma_f32_16x16x32_bf16 v[32:35], v[88:91], v[80:83], v[32:35]
    v_mfma_f32_16x16x32_bf16 v[36:39], v[92:95], v[80:83], v[36:39]
    v_mfma_f32_16x16x32_bf16 v[40:43], v[88:91], v[84:87], v[40:43]
    v_mfma_f32_16x16x32_bf16 v[44:47], v[92:95], v[84:87], v[44:47]
    s_waitcnt lgkmcnt(4)
    v_mfma_f32_16x16x32_bf16 v[32:35], v[104:107], v[96:99], v[32:35]
    v_mfma_f32_16x16x32_bf16 v[36:39], v[108:111], v[96:99], v[36:39]
    v_mfma_f32_16x16x32_bf16 v[40:43], v[104:107], v[100:103], v[40:43]
    v_mfma_f32_16x16x32_bf16 v[44:47], v[108:111], v[100:103], v[44:47]
    s_waitcnt lgkmcnt(0)
    v_mfma_f32_16x16x32_bf16 v[32:35], v[120:123], v[112:115], v[32:35]
    v_mfma_f32_16x16x32_bf16 v[36:39], v[124:127], v[112:115], v[36:39]
    v_mfma_f32_16x16x32_bf16 v[40:43], v[120:123], v[116:119], v[40:43]
    v_mfma_f32_16x16x32_bf16 v[44:47], v[124:127], v[116:119], v[44:47]
    s_barrier
    s_nop 7
    s_mov_b32 s56, 0x4038aa3b
    v_mul_f32 v32, s56, v32
    v_mul_f32 v33, s56, v33
    v_mul_f32 v34, s56, v34
    v_mul_f32 v35, s56, v35
    v_mul_f32 v36, s56, v36
    v_mul_f32 v37, s56, v37
    v_mul_f32 v38, s56, v38
    v_mul_f32 v39, s56, v39
    v_mul_f32 v40, s56, v40
    v_mul_f32 v41, s56, v41
    v_mul_f32 v42, s56, v42
    v_mul_f32 v43, s56, v43
    v_mul_f32 v44, s56, v44
    v_mul_f32 v45, s56, v45
    v_mul_f32 v46, s56, v46
    v_mul_f32 v47, s56, v47
    s_cmp_eq_u32 s85, 0
    s_cbranch_scc0 Lr_34
    v_med3_f32 v32, v32, v7, v6
    v_med3_f32 v33, v33, v7, v6
    v_med3_f32 v34, v34, v7, v6
    v_med3_f32 v35, v35, v7, v6
    v_med3_f32 v36, v36, v7, v6
    v_med3_f32 v37, v37, v7, v6
    v_med3_f32 v38, v38, v7, v6
    v_med3_f32 v39, v39, v7, v6
    v_med3_f32 v40, v40, v7, v6
    v_med3_f32 v41, v41, v7, v6
    v_med3_f32 v42, v42, v7, v6
    v_med3_f32 v43, v43, v7, v6
    v_med3_f32 v44, v44, v7, v6
    v_med3_f32 v45, v45, v7, v6
    v_med3_f32 v46, v46, v7, v6
    v_med3_f32 v47, v47, v7, v6
    v_exp_f32 v32, v32
    v_exp_f32 v33, v33
    v_exp_f32 v34, v34
    v_exp_f32 v35, v35
    v_exp_f32 v36, v36
    v_exp_f32 v37, v37
    v_exp_f32 v38, v38
    v_exp_f32 v39, v39
    v_exp_f32 v40, v40
    v_exp_f32 v41, v41
    v_exp_f32 v42, v42
    v_exp_f32 v43, v43
    v_exp_f32 v44, v44
    v_exp_f32 v45, v45
    v_exp_f32 v46, v46
    v_exp_f32 v47, v47
Lr_34:
    s_cmp_eq_u32 s87, 0
    s_cbranch_scc1 Ls_35
    buffer_store_dwordx4 v[32:35], v240, s[16:19], s73 offen offset:0
    buffer_store_dwordx4 v[36:39], v240, s[16:19], s73 offen offset:64
    buffer_store_dwordx4 v[40:43], v241, s[16:19], s73 offen offset:0
    buffer_store_dwordx4 v[44:47], v241, s[16:19], s73 offen offset:64
    s_branch Ls_36
Ls_35:
    buffer_store_dwordx4 v[32:35], v240, s[16:19], s73 offen offset:0 sc1
    buffer_store_dwordx4 v[36:39], v240, s[16:19], s73 offen offset:64 sc1
    buffer_store_dwordx4 v[40:43], v241, s[16:19], s73 offen offset:0 sc1
    buffer_store_dwordx4 v[44:47], v241, s[16:19], s73 offen offset:64 sc1
Ls_36:
    s_waitcnt vmcnt(0)
    v_mov_b32 v2, s86
    v_mov_b32 v3, s76
    s_mov_b64 s[70:71], exec
    s_mov_b64 exec, 1
    s_cmp_eq_u32 s87, 0
    s_cbranch_scc1 Lf_37
    buffer_store_dword v2, v3, s[16:19], 0 offen
    s_branch Lf_38
Lf_37:
    buffer_store_dword v2, v3, s[16:19], 0 offen sc1
Lf_38:
    s_mov_b64 exec, s[70:71]
    s_lshl_b32 s60, s55, 17
    s_add_u32 s60, s60, 13631488
    v_lshlrev_b32 v4, 4, v0
    buffer_load_dwordx4 v[48:51], v4, s[16:19], s60 offen offset:0
    buffer_load_dwordx4 v[52:55], v4, s[16:19], s60 offen offset:1024
    buffer_load_dwordx4 v[56:59], v4, s[16:19], s60 offen offset:2048
    buffer_load_dwordx4 v[60:63], v4, s[16:19], s60 offen offset:3072
    s_add_u32 s60, s60, 4096
    buffer_load_dwordx4 v[64:67], v4, s[16:19], s60 offen offset:0
    buffer_load_dwordx4 v[68:71], v4, s[16:19], s60 offen offset:1024
    v_and_b32 v2, 31, v0
    v_lshrrev_b32 v3, 5, v0
    v_lshlrev_b32 v5, 10, v3
    v_lshl_add_u32 v5, v2, 4, v5
    s_lshl_b32 s56, s55, 7
    s_add_u32 s56, s56, 98304
    v_lshlrev_b32 v7, 11, v3
    v_lshl_add_u32 v7, v2, 2, v7
    v_add_u32 v7, s56, v7
    s_barrier
    buffer_load_dwordx4 v[72:75], v4, s[16:19], s60 offen offset:2048
    buffer_load_dwordx4 v[76:79], v4, s[16:19], s60 offen offset:3072
    s_add_u32 s60, s60, 4096
    buffer_load_dwordx4 v[80:83], v4, s[16:19], s60 offen offset:0
    buffer_load_dwordx4 v[84:87], v4, s[16:19], s60 offen offset:1024
    buffer_load_dwordx4 v[88:91], v4, s[16:19], s60 offen offset:2048
    buffer_load_dwordx4 v[92:95], v4, s[16:19], s60 offen offset:3072
    s_add_u32 s60, s60, 4096
    buffer_load_dwordx4 v[96:99], v4, s[16:19], s60 offen offset:0
    buffer_load_dwordx4 v[100:103], v4, s[16:19], s60 offen offset:1024
    buffer_load_dwordx4 v[104:107], v4, s[16:19], s60 offen offset:2048
    buffer_load_dwordx4 v[108:111], v4, s[16:19], s60 offen offset:3072
    s_add_u32 s60, s60, 4096
    buffer_load_dwordx4 v[112:115], v4, s[16:19], s60 offen offset:0
    buffer_load_dwordx4 v[116:119], v4, s[16:19], s60 offen offset:1024
    buffer_load_dwordx4 v[120:123], v4, s[16:19], s60 offen offset:2048
    buffer_load_dwordx4 v[124:127], v4, s[16:19], s60 offen offset:3072
    s_add_u32 s60, s60, 4096
    s_barrier
    ds_read_b128 v[12:15], v5 offset:0
    ds_read_b128 v[16:19], v5 offset:512
    ds_read_b128 v[20:23], v5 offset:2048
    ds_read_b128 v[24:27], v5 offset:2560
    s_waitcnt vmcnt(14) lgkmcnt(0)
    v_mfma_f32_32x32x16_bf16 v[128:143], v[12:15], v[48:51], 0
    ds_read_b128 v[28:31], v5 offset:4096
    v_mfma_f32_32x32x16_bf16 v[160:175], v[12:15], v[52:55], 0
    ds_read_b128 v[32:35], v5 offset:4608
    v_mfma_f32_32x32x16_bf16 v[192:207], v[12:15], v[56:59], 0
    ds_read_b128 v[36:39], v5 offset:6144
    v_mfma_f32_32x32x16_bf16 v[144:159], v[16:19], v[48:51], 0
    ds_read_b128 v[40:43], v5 offset:6656
    v_mfma_f32_32x32x16_bf16 v[176:191], v[16:19], v[52:55], 0
    v_mfma_f32_32x32x16_bf16 v[208:223], v[16:19], v[56:59], 0
    v_mfma_f32_32x32x16_bf16 v[128:143], v[20:23], v[60:63], v[128:143]
    v_mfma_f32_32x32x16_bf16 v[160:175], v[20:23], v[64:67], v[160:175]
    v_mfma_f32_32x32x16_bf16 v[192:207], v[20:23], v[68:71], v[192:207]
    v_mfma_f32_32x32x16_bf16 v[144:159], v[24:27], v[60:63], v[144:159]
    v_mfma_f32_32x32x16_bf16 v[176:191], v[24:27], v[64:67], v[176:191]
    v_mfma_f32_32x32x16_bf16 v[208:223], v[24:27], v[68:71], v[208:223]
    s_waitcnt vmcnt(8) lgkmcnt(0)
    s_barrier
    v_mfma_f32_32x32x16_bf16 v[128:143], v[28:31], v[72:75], v[128:143]
    ds_read_b128 v[12:15], v5 offset:8192
    v_mfma_f32_32x32x16_bf16 v[160:175], v[28:31], v[76:79], v[160:175]
    ds_read_b128 v[16:19], v5 offset:8704
    v_mfma_f32_32x32x16_bf16 v[192:207], v[28:31], v[80:83], v[192:207]
    ds_read_b128 v[20:23], v5 offset:10240
    v_mfma_f32_32x32x16_bf16 v[144:159], v[32:35], v[72:75], v[144:159]
    ds_read_b128 v[24:27], v5 offset:10752
    v_mfma_f32_32x32x16_bf16 v[176:191], v[32:35], v[76:79], v[176:191]
    buffer_load_dwordx4 v[48:51], v4, s[16:19], s60 offen offset:0
    v_mfma_f32_32x32x16_bf16 v[208:223], v[32:35], v[80:83], v[208:223]
    buffer_load_dwordx4 v[52:55], v4, s[16:19], s60 offen offset:1024
    v_mfma_f32_32x32x16_bf16 v[128:143], v[36:39], v[84:87], v[128:143]
    buffer_load_dwordx4 v[56:59], v4, s[16:19], s60 offen offset:2048
    v_mfma_f32_32x32x16_bf16 v[160:175], v[36:39], v[88:91], v[160:175]
    buffer_load_dwordx4 v[60:63], v4, s[16:19], s60 offen offset:3072
    v_mfma_f32_32x32x16_bf16 v[192:207], v[36:39], v[92:95], v[192:207]
    s_add_u32 s60, s60, 4096
    v_mfma_f32_32x32x16_bf16 v[144:159], v[40:43], v[84:87], v[144:159]
    buffer_load_dwordx4 v[64:67], v4, s[16:19], s60 offen offset:0
    v_mfma_f32_32x32x16_bf16 v[176:191], v[40:43], v[88:91], v[176:191]
    buffer_load_dwordx4 v[68:71], v4, s[16:19], s60 offen offset:1024
    v_mfma_f32_32x32x16_bf16 v[208:223], v[40:43], v[92:95], v[208:223]
    s_waitcnt vmcnt(8) lgkmcnt(0)
    s_barrier
    v_mfma_f32_32x32x16_bf16 v[128:143], v[12:15], v[96:99], v[128:143]
    ds_read_b128 v[28:31], v5 offset:12288
    v_mfma_f32_32x32x16_bf16 v[160:175], v[12:15], v[100:103], v[160:175]
    ds_read_b128 v[32:35], v5 offset:12800
    v_mfma_f32_32x32x16_bf16 v[192:207], v[12:15], v[104:107], v[192:207]
    ds_read_b128 v[36:39], v5 offset:14336
    v_mfma_f32_32x32x16_bf16 v[144:159], v[16:19], v[96:99], v[144:159]
    ds_read_b128 v[40:43], v5 offset:14848
    v_mfma_f32_32x32x16_bf16 v[176:191], v[16:19], v[100:103], v[176:191]
    buffer_load_dwordx4 v[72:75], v4, s[16:19], s60 offen offset:2048
    v_mfma_f32_32x32x16_bf16 v[208:223], v[16:19], v[104:107], v[208:223]
    buffer_load_dwordx4 v[76:79], v4, s[16:19], s60 offen offset:3072
    v_mfma_f32_32x32x16_bf16 v[128:143], v[20:23], v[108:111], v[128:143]
    s_add_u32 s60, s60, 4096
    v_mfma_f32_32x32x16_bf16 v[160:175], v[20:23], v[112:115], v[160:175]
    buffer_load_dwordx4 v[80:83], v4, s[16:19], s60 offen offset:0
    v_mfma_f32_32x32x16_bf16 v[192:207], v[20:23], v[116:119], v[192:207]
    buffer_load_dwordx4 v[84:87], v4, s[16:19], s60 offen offset:1024
    v_mfma_f32_32x32x16_bf16 v[144:159], v[24:27], v[108:111], v[144:159]
    buffer_load_dwordx4 v[88:91], v4, s[16:19], s60 offen offset:2048
    v_mfma_f32_32x32x16_bf16 v[176:191], v[24:27], v[112:115], v[176:191]
    buffer_load_dwordx4 v[92:95], v4, s[16:19], s60 offen offset:3072
    v_mfma_f32_32x32x16_bf16 v[208:223], v[24:27], v[116:119], v[208:223]
    s_add_u32 s60, s60, 4096
    s_waitcnt vmcnt(8) lgkmcnt(0)
    s_barrier
    v_mfma_f32_32x32x16_bf16 v[128:143], v[28:31], v[120:123], v[128:143]
    ds_read_b128 v[12:15], v5 offset:16384
    v_mfma_f32_32x32x16_bf16 v[160:175], v[28:31], v[124:127], v[160:175]
    ds_read_b128 v[16:19], v5 offset:16896
    v_mfma_f32_32x32x16_bf16 v[192:207], v[28:31], v[48:51], v[192:207]
    ds_read_b128 v[20:23], v5 offset:18432
    v_mfma_f32_32x32x16_bf16 v[144:159], v[32:35], v[120:123], v[144:159]
    ds_read_b128 v[24:27], v5 offset:18944
    v_mfma_f32_32x32x16_bf16 v[176:191], v[32:35], v[124:127], v[176:191]
    buffer_load_dwordx4 v[96:99], v4, s[16:19], s60 offen offset:0
    v_mfma_f32_32x32x16_bf16 v[208:223], v[32:35], v[48:51], v[208:223]
    buffer_load_dwordx4 v[100:103], v4, s[16:19], s60 offen offset:1024
    v_mfma_f32_32x32x16_bf16 v[128:143], v[36:39], v[52:55], v[128:143]
    buffer_load_dwordx4 v[104:107], v4, s[16:19], s60 offen offset:2048
    v_mfma_f32_32x32x16_bf16 v[160:175], v[36:39], v[56:59], v[160:175]
    buffer_load_dwordx4 v[108:111], v4, s[16:19], s60 offen offset:3072
    v_mfma_f32_32x32x16_bf16 v[192:207], v[36:39], v[60:63], v[192:207]
    s_add_u32 s60, s60, 4096
    v_mfma_f32_32x32x16_bf16 v[144:159], v[40:43], v[52:55], v[144:159]
    buffer_load_dwordx4 v[112:115], v4, s[16:19], s60 offen offset:0
    v_mfma_f32_32x32x16_bf16 v[176:191], v[40:43], v[56:59], v[176:191]
    buffer_load_dwordx4 v[116:119], v4, s[16:19], s60 offen offset:1024
    v_mfma_f32_32x32x16_bf16 v[208:223], v[40:43], v[60:63], v[208:223]
    s_waitcnt vmcnt(8) lgkmcnt(0)
    s_barrier
    v_mfma_f32_32x32x16_bf16 v[128:143], v[12:15], v[64:67], v[128:143]
    ds_read_b128 v[28:31], v5 offset:20480
    v_mfma_f32_32x32x16_bf16 v[160:175], v[12:15], v[68:71], v[160:175]
    ds_read_b128 v[32:35], v5 offset:20992
    v_mfma_f32_32x32x16_bf16 v[192:207], v[12:15], v[72:75], v[192:207]
    ds_read_b128 v[36:39], v5 offset:22528
    v_mfma_f32_32x32x16_bf16 v[144:159], v[16:19], v[64:67], v[144:159]
    ds_read_b128 v[40:43], v5 offset:23040
    v_mfma_f32_32x32x16_bf16 v[176:191], v[16:19], v[68:71], v[176:191]
    buffer_load_dwordx4 v[120:123], v4, s[16:19], s60 offen offset:2048
    v_mfma_f32_32x32x16_bf16 v[208:223], v[16:19], v[72:75], v[208:223]
    buffer_load_dwordx4 v[124:127], v4, s[16:19], s60 offen offset:3072
    v_mfma_f32_32x32x16_bf16 v[128:143], v[20:23], v[76:79], v[128:143]
    s_add_u32 s60, s60, 4096
    v_mfma_f32_32x32x16_bf16 v[160:175], v[20:23], v[80:83], v[160:175]
    buffer_load_dwordx4 v[48:51], v4, s[16:19], s60 offen offset:0
    v_mfma_f32_32x32x16_bf16 v[192:207], v[20:23], v[84:87], v[192:207]
    buffer_load_dwordx4 v[52:55], v4, s[16:19], s60 offen offset:1024
    v_mfma_f32_32x32x16_bf16 v[144:159], v[24:27], v[76:79], v[144:159]
    buffer_load_dwordx4 v[56:59], v4, s[16:19], s60 offen offset:2048
    v_mfma_f32_32x32x16_bf16 v[176:191], v[24:27], v[80:83], v[176:191]
    buffer_load_dwordx4 v[60:63], v4, s[16:19], s60 offen offset:3072
    v_mfma_f32_32x32x16_bf16 v[208:223], v[24:27], v[84:87], v[208:223]
    s_add_u32 s60, s60, 4096
    s_waitcnt vmcnt(8) lgkmcnt(0)
    s_barrier
    v_mfma_f32_32x32x16_bf16 v[128:143], v[28:31], v[88:91], v[128:143]
    ds_read_b128 v[12:15], v5 offset:24576
    v_mfma_f32_32x32x16_bf16 v[160:175], v[28:31], v[92:95], v[160:175]
    ds_read_b128 v[16:19], v5 offset:25088
    v_mfma_f32_32x32x16_bf16 v[192:207], v[28:31], v[96:99], v[192:207]
    ds_read_b128 v[20:23], v5 offset:26624
    v_mfma_f32_32x32x16_bf16 v[144:159], v[32:35], v[88:91], v[144:159]
    ds_read_b128 v[24:27], v5 offset:27136
    v_mfma_f32_32x32x16_bf16 v[176:191], v[32:35], v[92:95], v[176:191]
    buffer_load_dwordx4 v[64:67], v4, s[16:19], s60 offen offset:0
    v_mfma_f32_32x32x16_bf16 v[208:223], v[32:35], v[96:99], v[208:223]
    buffer_load_dwordx4 v[68:71], v4, s[16:19], s60 offen offset:1024
    v_mfma_f32_32x32x16_bf16 v[128:143], v[36:39], v[100:103], v[128:143]
    buffer_load_dwordx4 v[72:75], v4, s[16:19], s60 offen offset:2048
    v_mfma_f32_32x32x16_bf16 v[160:175], v[36:39], v[104:107], v[160:175]
    buffer_load_dwordx4 v[76:79], v4, s[16:19], s60 offen offset:3072
    v_mfma_f32_32x32x16_bf16 v[192:207], v[36:39], v[108:111], v[192:207]
    s_add_u32 s60, s60, 4096
    v_mfma_f32_32x32x16_bf16 v[144:159], v[40:43], v[100:103], v[144:159]
    buffer_load_dwordx4 v[80:83], v4, s[16:19], s60 offen offset:0
    v_mfma_f32_32x32x16_bf16 v[176:191], v[40:43], v[104:107], v[176:191]
    buffer_load_dwordx4 v[84:87], v4, s[16:19], s60 offen offset:1024
    v_mfma_f32_32x32x16_bf16 v[208:223], v[40:43], v[108:111], v[208:223]
    s_waitcnt vmcnt(8) lgkmcnt(0)
    s_barrier
    v_mfma_f32_32x32x16_bf16 v[128:143], v[12:15], v[112:115], v[128:143]
    ds_read_b128 v[28:31], v5 offset:28672
    v_mfma_f32_32x32x16_bf16 v[160:175], v[12:15], v[116:119], v[160:175]
    ds_read_b128 v[32:35], v5 offset:29184
    v_mfma_f32_32x32x16_bf16 v[192:207], v[12:15], v[120:123], v[192:207]
    ds_read_b128 v[36:39], v5 offset:30720
    v_mfma_f32_32x32x16_bf16 v[144:159], v[16:19], v[112:115], v[144:159]
    ds_read_b128 v[40:43], v5 offset:31232
    v_mfma_f32_32x32x16_bf16 v[176:191], v[16:19], v[116:119], v[176:191]
    buffer_load_dwordx4 v[88:91], v4, s[16:19], s60 offen offset:2048
    v_mfma_f32_32x32x16_bf16 v[208:223], v[16:19], v[120:123], v[208:223]
    buffer_load_dwordx4 v[92:95], v4, s[16:19], s60 offen offset:3072
    v_mfma_f32_32x32x16_bf16 v[128:143], v[20:23], v[124:127], v[128:143]
    s_add_u32 s60, s60, 4096
    v_mfma_f32_32x32x16_bf16 v[160:175], v[20:23], v[48:51], v[160:175]
    buffer_load_dwordx4 v[96:99], v4, s[16:19], s60 offen offset:0
    v_mfma_f32_32x32x16_bf16 v[192:207], v[20:23], v[52:55], v[192:207]
    buffer_load_dwordx4 v[100:103], v4, s[16:19], s60 offen offset:1024
    v_mfma_f32_32x32x16_bf16 v[144:159], v[24:27], v[124:127], v[144:159]
    buffer_load_dwordx4 v[104:107], v4, s[16:19], s60 offen offset:2048
    v_mfma_f32_32x32x16_bf16 v[176:191], v[24:27], v[48:51], v[176:191]
    buffer_load_dwordx4 v[108:111], v4, s[16:19], s60 offen offset:3072
    v_mfma_f32_32x32x16_bf16 v[208:223], v[24:27], v[52:55], v[208:223]
    s_add_u32 s60, s60, 4096
    s_waitcnt vmcnt(8) lgkmcnt(0)
    s_barrier
    v_mfma_f32_32x32x16_bf16 v[128:143], v[28:31], v[56:59], v[128:143]
    ds_read_b128 v[12:15], v5 offset:32768
    v_mfma_f32_32x32x16_bf16 v[160:175], v[28:31], v[60:63], v[160:175]
    ds_read_b128 v[16:19], v5 offset:33280
    v_mfma_f32_32x32x16_bf16 v[192:207], v[28:31], v[64:67], v[192:207]
    ds_read_b128 v[20:23], v5 offset:34816
    v_mfma_f32_32x32x16_bf16 v[144:159], v[32:35], v[56:59], v[144:159]
    ds_read_b128 v[24:27], v5 offset:35328
    v_mfma_f32_32x32x16_bf16 v[176:191], v[32:35], v[60:63], v[176:191]
    buffer_load_dwordx4 v[112:115], v4, s[16:19], s60 offen offset:0
    v_mfma_f32_32x32x16_bf16 v[208:223], v[32:35], v[64:67], v[208:223]
    buffer_load_dwordx4 v[116:119], v4, s[16:19], s60 offen offset:1024
    v_mfma_f32_32x32x16_bf16 v[128:143], v[36:39], v[68:71], v[128:143]
    buffer_load_dwordx4 v[120:123], v4, s[16:19], s60 offen offset:2048
    v_mfma_f32_32x32x16_bf16 v[160:175], v[36:39], v[72:75], v[160:175]
    buffer_load_dwordx4 v[124:127], v4, s[16:19], s60 offen offset:3072
    v_mfma_f32_32x32x16_bf16 v[192:207], v[36:39], v[76:79], v[192:207]
    s_add_u32 s60, s60, 4096
    v_mfma_f32_32x32x16_bf16 v[144:159], v[40:43], v[68:71], v[144:159]
    buffer_load_dwordx4 v[48:51], v4, s[16:19], s60 offen offset:0
    v_mfma_f32_32x32x16_bf16 v[176:191], v[40:43], v[72:75], v[176:191]
    buffer_load_dwordx4 v[52:55], v4, s[16:19], s60 offen offset:1024
    v_mfma_f32_32x32x16_bf16 v[208:223], v[40:43], v[76:79], v[208:223]
    s_waitcnt vmcnt(8) lgkmcnt(0)
    s_barrier
    v_mfma_f32_32x32x16_bf16 v[128:143], v[12:15], v[80:83], v[128:143]
    ds_read_b128 v[28:31], v5 offset:36864
    v_mfma_f32_32x32x16_bf16 v[160:175], v[12:15], v[84:87], v[160:175]
    ds_read_b128 v[32:35], v5 offset:37376
    v_mfma_f32_32x32x16_bf16 v[192:207], v[12:15], v[88:91], v[192:207]
    ds_read_b128 v[36:39], v5 offset:38912
    v_mfma_f32_32x32x16_bf16 v[144:159], v[16:19], v[80:83], v[144:159]
    ds_read_b128 v[40:43], v5 offset:39424
    v_mfma_f32_32x32x16_bf16 v[176:191], v[16:19], v[84:87], v[176:191]
    buffer_load_dwordx4 v[56:59], v4, s[16:19], s60 offen offset:2048
    v_mfma_f32_32x32x16_bf16 v[208:223], v[16:19], v[88:91], v[208:223]
    buffer_load_dwordx4 v[60:63], v4, s[16:19], s60 offen offset:3072
    v_mfma_f32_32x32x16_bf16 v[128:143], v[20:23], v[92:95], v[128:143]
    s_add_u32 s60, s60, 4096
    v_mfma_f32_32x32x16_bf16 v[160:175], v[20:23], v[96:99], v[160:175]
    buffer_load_dwordx4 v[64:67], v4, s[16:19], s60 offen offset:0
    v_mfma_f32_32x32x16_bf16 v[192:207], v[20:23], v[100:103], v[192:207]
    buffer_load_dwordx4 v[68:71], v4, s[16:19], s60 offen offset:1024
    v_mfma_f32_32x32x16_bf16 v[144:159], v[24:27], v[92:95], v[144:159]
    buffer_load_dwordx4 v[72:75], v4, s[16:19], s60 offen offset:2048
    v_mfma_f32_32x32x16_bf16 v[176:191], v[24:27], v[96:99], v[176:191]
    buffer_load_dwordx4 v[76:79], v4, s[16:19], s60 offen offset:3072
    v_mfma_f32_32x32x16_bf16 v[208:223], v[24:27], v[100:103], v[208:223]
    s_add_u32 s60, s60, 4096
    s_waitcnt vmcnt(8) lgkmcnt(0)
    s_barrier
    v_mfma_f32_32x32x16_bf16 v[128:143], v[28:31], v[104:107], v[128:143]
    ds_read_b128 v[12:15], v5 offset:40960
    v_mfma_f32_32x32x16_bf16 v[160:175], v[28:31], v[108:111], v[160:175]
    ds_read_b128 v[16:19], v5 offset:41472
    v_mfma_f32_32x32x16_bf16 v[192:207], v[28:31], v[112:115], v[192:207]
    ds_read_b128 v[20:23], v5 offset:43008
    v_mfma_f32_32x32x16_bf16 v[144:159], v[32:35], v[104:107], v[144:159]
    ds_read_b128 v[24:27], v5 offset:43520
    v_mfma_f32_32x32x16_bf16 v[176:191], v[32:35], v[108:111], v[176:191]
    buffer_load_dwordx4 v[80:83], v4, s[16:19], s60 offen offset:0
    v_mfma_f32_32x32x16_bf16 v[208:223], v[32:35], v[112:115], v[208:223]
    buffer_load_dwordx4 v[84:87], v4, s[16:19], s60 offen offset:1024
    v_mfma_f32_32x32x16_bf16 v[128:143], v[36:39], v[116:119], v[128:143]
    buffer_load_dwordx4 v[88:91], v4, s[16:19], s60 offen offset:2048
    v_mfma_f32_32x32x16_bf16 v[160:175], v[36:39], v[120:123], v[160:175]
    buffer_load_dwordx4 v[92:95], v4, s[16:19], s60 offen offset:3072
    v_mfma_f32_32x32x16_bf16 v[192:207], v[36:39], v[124:127], v[192:207]
    s_add_u32 s60, s60, 4096
    v_mfma_f32_32x32x16_bf16 v[144:159], v[40:43], v[116:119], v[144:159]
    buffer_load_dwordx4 v[96:99], v4, s[16:19], s60 offen offset:0
    v_mfma_f32_32x32x16_bf16 v[176:191], v[40:43], v[120:123], v[176:191]
    buffer_load_dwordx4 v[100:103], v4, s[16:19], s60 offen offset:1024
    v_mfma_f32_32x32x16_bf16 v[208:223], v[40:43], v[124:127], v[208:223]
    s_waitcnt vmcnt(8) lgkmcnt(0)
    s_barrier
    v_mfma_f32_32x32x16_bf16 v[128:143], v[12:15], v[48:51], v[128:143]
    ds_read_b128 v[28:31], v5 offset:45056
    v_mfma_f32_32x32x16_bf16 v[160:175], v[12:15], v[52:55], v[160:175]
    ds_read_b128 v[32:35], v5 offset:45568
    v_mfma_f32_32x32x16_bf16 v[192:207], v[12:15], v[56:59], v[192:207]
    ds_read_b128 v[36:39], v5 offset:47104
    v_mfma_f32_32x32x16_bf16 v[144:159], v[16:19], v[48:51], v[144:159]
    ds_read_b128 v[40:43], v5 offset:47616
    v_mfma_f32_32x32x16_bf16 v[176:191], v[16:19], v[52:55], v[176:191]
    buffer_load_dwordx4 v[104:107], v4, s[16:19], s60 offen offset:2048
    v_mfma_f32_32x32x16_bf16 v[208:223], v[16:19], v[56:59], v[208:223]
    buffer_load_dwordx4 v[108:111], v4, s[16:19], s60 offen offset:3072
    v_mfma_f32_32x32x16_bf16 v[128:143], v[20:23], v[60:63], v[128:143]
    s_add_u32 s60, s60, 4096
    v_mfma_f32_32x32x16_bf16 v[160:175], v[20:23], v[64:67], v[160:175]
    buffer_load_dwordx4 v[112:115], v4, s[16:19], s60 offen offset:0
    v_mfma_f32_32x32x16_bf16 v[192:207], v[20:23], v[68:71], v[192:207]
    buffer_load_dwordx4 v[116:119], v4, s[16:19], s60 offen offset:1024
    v_mfma_f32_32x32x16_bf16 v[144:159], v[24:27], v[60:63], v[144:159]
    buffer_load_dwordx4 v[120:123], v4, s[16:19], s60 offen offset:2048
    v_mfma_f32_32x32x16_bf16 v[176:191], v[24:27], v[64:67], v[176:191]
    buffer_load_dwordx4 v[124:127], v4, s[16:19], s60 offen offset:3072
    v_mfma_f32_32x32x16_bf16 v[208:223], v[24:27], v[68:71], v[208:223]
    s_add_u32 s60, s60, 4096
    s_waitcnt vmcnt(8) lgkmcnt(0)
    s_barrier
    v_mfma_f32_32x32x16_bf16 v[128:143], v[28:31], v[72:75], v[128:143]
    ds_read_b128 v[12:15], v5 offset:49152
    v_mfma_f32_32x32x16_bf16 v[160:175], v[28:31], v[76:79], v[160:175]
    ds_read_b128 v[16:19], v5 offset:49664
    v_mfma_f32_32x32x16_bf16 v[192:207], v[28:31], v[80:83], v[192:207]
    ds_read_b128 v[20:23], v5 offset:51200
    v_mfma_f32_32x32x16_bf16 v[144:159], v[32:35], v[72:75], v[144:159]
    ds_read_b128 v[24:27], v5 offset:51712
    v_mfma_f32_32x32x16_bf16 v[176:191], v[32:35], v[76:79], v[176:191]
    buffer_load_dwordx4 v[48:51], v4, s[16:19], s60 offen offset:0
    v_mfma_f32_32x32x16_bf16 v[208:223], v[32:35], v[80:83], v[208:223]
    buffer_load_dwordx4 v[52:55], v4, s[16:19], s60 offen offset:1024
    v_mfma_f32_32x32x16_bf16 v[128:143], v[36:39], v[84:87], v[128:143]
    buffer_load_dwordx4 v[56:59], v4, s[16:19], s60 offen offset:2048
    v_mfma_f32_32x32x16_bf16 v[160:175], v[36:39], v[88:91], v[160:175]
    buffer_load_dwordx4 v[60:63], v4, s[16:19], s60 offen offset:3072
    v_mfma_f32_32x32x16_bf16 v[192:207], v[36:39], v[92:95], v[192:207]
    s_add_u32 s60, s60, 4096
    v_mfma_f32_32x32x16_bf16 v[144:159], v[40:43], v[84:87], v[144:159]
    buffer_load_dwordx4 v[64:67], v4, s[16:19], s60 offen offset:0
    v_mfma_f32_32x32x16_bf16 v[176:191], v[40:43], v[88:91], v[176:191]
    buffer_load_dwordx4 v[68:71], v4, s[16:19], s60 offen offset:1024
    v_mfma_f32_32x32x16_bf16 v[208:223], v[40:43], v[92:95], v[208:223]
    s_waitcnt vmcnt(8) lgkmcnt(0)
    s_barrier
    v_mfma_f32_32x32x16_bf16 v[128:143], v[12:15], v[96:99], v[128:143]
    ds_read_b128 v[28:31], v5 offset:53248
    v_mfma_f32_32x32x16_bf16 v[160:175], v[12:15], v[100:103], v[160:175]
    ds_read_b128 v[32:35], v5 offset:53760
    v_mfma_f32_32x32x16_bf16 v[192:207], v[12:15], v[104:107], v[192:207]
    ds_read_b128 v[36:39], v5 offset:55296
    v_mfma_f32_32x32x16_bf16 v[144:159], v[16:19], v[96:99], v[144:159]
    ds_read_b128 v[40:43], v5 offset:55808
    v_mfma_f32_32x32x16_bf16 v[176:191], v[16:19], v[100:103], v[176:191]
    buffer_load_dwordx4 v[72:75], v4, s[16:19], s60 offen offset:2048
    v_mfma_f32_32x32x16_bf16 v[208:223], v[16:19], v[104:107], v[208:223]
    buffer_load_dwordx4 v[76:79], v4, s[16:19], s60 offen offset:3072
    v_mfma_f32_32x32x16_bf16 v[128:143], v[20:23], v[108:111], v[128:143]
    s_add_u32 s60, s60, 4096
    v_mfma_f32_32x32x16_bf16 v[160:175], v[20:23], v[112:115], v[160:175]
    buffer_load_dwordx4 v[80:83], v4, s[16:19], s60 offen offset:0
    v_mfma_f32_32x32x16_bf16 v[192:207], v[20:23], v[116:119], v[192:207]
    buffer_load_dwordx4 v[84:87], v4, s[16:19], s60 offen offset:1024
    v_mfma_f32_32x32x16_bf16 v[144:159], v[24:27], v[108:111], v[144:159]
    buffer_load_dwordx4 v[88:91], v4, s[16:19], s60 offen offset:2048
    v_mfma_f32_32x32x16_bf16 v[176:191], v[24:27], v[112:115], v[176:191]
    buffer_load_dwordx4 v[92:95], v4, s[16:19], s60 offen offset:3072
    v_mfma_f32_32x32x16_bf16 v[208:223], v[24:27], v[116:119], v[208:223]
    s_add_u32 s60, s60, 4096
    s_waitcnt vmcnt(8) lgkmcnt(0)
    s_barrier
    v_mfma_f32_32x32x16_bf16 v[128:143], v[28:31], v[120:123], v[128:143]
    ds_read_b128 v[12:15], v5 offset:57344
    v_mfma_f32_32x32x16_bf16 v[160:175], v[28:31], v[124:127], v[160:175]
    ds_read_b128 v[16:19], v5 offset:57856
    v_mfma_f32_32x32x16_bf16 v[192:207], v[28:31], v[48:51], v[192:207]
    ds_read_b128 v[20:23], v5 offset:59392
    v_mfma_f32_32x32x16_bf16 v[144:159], v[32:35], v[120:123], v[144:159]
    ds_read_b128 v[24:27], v5 offset:59904
    v_mfma_f32_32x32x16_bf16 v[176:191], v[32:35], v[124:127], v[176:191]
    buffer_load_dwordx4 v[96:99], v4, s[16:19], s60 offen offset:0
    v_mfma_f32_32x32x16_bf16 v[208:223], v[32:35], v[48:51], v[208:223]
    buffer_load_dwordx4 v[100:103], v4, s[16:19], s60 offen offset:1024
    v_mfma_f32_32x32x16_bf16 v[128:143], v[36:39], v[52:55], v[128:143]
    buffer_load_dwordx4 v[104:107], v4, s[16:19], s60 offen offset:2048
    v_mfma_f32_32x32x16_bf16 v[160:175], v[36:39], v[56:59], v[160:175]
    buffer_load_dwordx4 v[108:111], v4, s[16:19], s60 offen offset:3072
    v_mfma_f32_32x32x16_bf16 v[192:207], v[36:39], v[60:63], v[192:207]
    s_add_u32 s60, s60, 4096
    v_mfma_f32_32x32x16_bf16 v[144:159], v[40:43], v[52:55], v[144:159]
    buffer_load_dwordx4 v[112:115], v4, s[16:19], s60 offen offset:0
    v_mfma_f32_32x32x16_bf16 v[176:191], v[40:43], v[56:59], v[176:191]
    buffer_load_dwordx4 v[116:119], v4, s[16:19], s60 offen offset:1024
    v_mfma_f32_32x32x16_bf16 v[208:223], v[40:43], v[60:63], v[208:223]
    s_waitcnt vmcnt(8) lgkmcnt(0)
    s_barrier
    v_mfma_f32_32x32x16_bf16 v[128:143], v[12:15], v[64:67], v[128:143]
    ds_read_b128 v[28:31], v5 offset:61440
    v_mfma_f32_32x32x16_bf16 v[160:175], v[12:15], v[68:71], v[160:175]
    ds_read_b128 v[32:35], v5 offset:61952
    v_mfma_f32_32x32x16_bf16 v[192:207], v[12:15], v[72:75], v[192:207]
    ds_read_b128 v[36:39], v5 offset:63488
    v_mfma_f32_32x32x16_bf16 v[144:159], v[16:19], v[64:67], v[144:159]
    ds_read_b128 v[40:43], v5 offset:64000
    v_mfma_f32_32x32x16_bf16 v[176:191], v[16:19], v[68:71], v[176:191]
    buffer_load_dwordx4 v[120:123], v4, s[16:19], s60 offen offset:2048
    v_mfma_f32_32x32x16_bf16 v[208:223], v[16:19], v[72:75], v[208:223]
    buffer_load_dwordx4 v[124:127], v4, s[16:19], s60 offen offset:3072
    v_mfma_f32_32x32x16_bf16 v[128:143], v[20:23], v[76:79], v[128:143]
    s_add_u32 s60, s60, 4096
    v_mfma_f32_32x32x16_bf16 v[160:175], v[20:23], v[80:83], v[160:175]
    buffer_load_dwordx4 v[48:51], v4, s[16:19], s60 offen offset:0
    v_mfma_f32_32x32x16_bf16 v[192:207], v[20:23], v[84:87], v[192:207]
    buffer_load_dwordx4 v[52:55], v4, s[16:19], s60 offen offset:1024
    v_mfma_f32_32x32x16_bf16 v[144:159], v[24:27], v[76:79], v[144:159]
    buffer_load_dwordx4 v[56:59], v4, s[16:19], s60 offen offset:2048
    v_mfma_f32_32x32x16_bf16 v[176:191], v[24:27], v[80:83], v[176:191]
    buffer_load_dwordx4 v[60:63], v4, s[16:19], s60 offen offset:3072
    v_mfma_f32_32x32x16_bf16 v[208:223], v[24:27], v[84:87], v[208:223]
    s_add_u32 s60, s60, 4096
    s_waitcnt vmcnt(8) lgkmcnt(0)
    v_mfma_f32_32x32x16_bf16 v[128:143], v[28:31], v[88:91], v[128:143]
    ds_read_b128 v[12:15], v5 offset:0
    v_mfma_f32_32x32x16_bf16 v[160:175], v[28:31], v[92:95], v[160:175]
    ds_read_b128 v[16:19], v5 offset:512
    v_mfma_f32_32x32x16_bf16 v[192:207], v[28:31], v[96:99], v[192:207]
    ds_read_b128 v[20:23], v5 offset:2048
    v_mfma_f32_32x32x16_bf16 v[144:159], v[32:35], v[88:91], v[144:159]
    ds_read_b128 v[24:27], v5 offset:2560
    v_mfma_f32_32x32x16_bf16 v[176:191], v[32:35], v[92:95], v[176:191]
    buffer_load_dwordx4 v[64:67], v4, s[16:19], s60 offen offset:0
    v_mfma_f32_32x32x16_bf16 v[208:223], v[32:35], v[96:99], v[208:223]
    buffer_load_dwordx4 v[68:71], v4, s[16:19], s60 offen offset:1024
    v_mfma_f32_32x32x16_bf16 v[128:143], v[36:39], v[100:103], v[128:143]
    buffer_load_dwordx4 v[72:75], v4, s[16:19], s60 offen offset:2048
    v_mfma_f32_32x32x16_bf16 v[160:175], v[36:39], v[104:107], v[160:175]
    buffer_load_dwordx4 v[76:79], v4, s[16:19], s60 offen offset:3072
    v_mfma_f32_32x32x16_bf16 v[192:207], v[36:39], v[108:111], v[192:207]
    s_add_u32 s60, s60, 4096
    v_mfma_f32_32x32x16_bf16 v[144:159], v[40:43], v[100:103], v[144:159]
    buffer_load_dwordx4 v[80:83], v4, s[16:19], s60 offen offset:0
    v_mfma_f32_32x32x16_bf16 v[176:191], v[40:43], v[104:107], v[176:191]
    buffer_load_dwordx4 v[84:87], v4, s[16:19], s60 offen offset:1024
    v_mfma_f32_32x32x16_bf16 v[208:223], v[40:43], v[108:111], v[208:223]
    s_waitcnt vmcnt(12) lgkmcnt(0)
    v_mfma_f32_32x32x16_bf16 v[224:239], v[12:15], v[112:115], 0
    ds_read_b128 v[28:31], v5 offset:4096
    ds_read_b128 v[32:35], v5 offset:4608
    ds_read_b128 v[36:39], v5 offset:6144
    ds_read_b128 v[40:43], v5 offset:6656
    buffer_load_dwordx4 v[88:91], v4, s[16:19], s60 offen offset:2048
    buffer_load_dwordx4 v[92:95], v4, s[16:19], s60 offen offset:3072
    v_mfma_f32_32x32x16_bf16 v[240:255], v[16:19], v[112:115], 0
    s_add_u32 s60, s60, 4096
    buffer_load_dwordx4 v[96:99], v4, s[16:19], s60 offen offset:0
    buffer_load_dwordx4 v[100:103], v4, s[16:19], s60 offen offset:1024
    buffer_load_dwordx4 v[104:107], v4, s[16:19], s60 offen offset:2048
    buffer_load_dwordx4 v[108:111], v4, s[16:19], s60 offen offset:3072
    s_add_u32 s60, s60, 4096
    v_mfma_f32_32x32x16_bf16 v[224:239], v[20:23], v[116:119], v[224:239]
    v_cvt_pk_bf16_f32 v44, v128, v160
    ds_write_b32 v7, v44 offset:0
    v_cvt_pk_bf16_f32 v45, v129, v161
    ds_write_b32 v7, v45 offset:512
    v_cvt_pk_bf16_f32 v46, v130, v162
    ds_write_b32 v7, v46 offset:1024
    v_mfma_f32_32x32x16_bf16 v[240:255], v[24:27], v[116:119], v[240:255]
    v_cvt_pk_bf16_f32 v47, v131, v163
    ds_write_b32 v7, v47 offset:1536
    v_cvt_pk_bf16_f32 v44, v132, v164
    ds_write_b32 v7, v44 offset:4096
    v_cvt_pk_bf16_f32 v45, v133, v165
    s_waitcnt vmcnt(16) lgkmcnt(0)
    v_mfma_f32_32x32x16_bf16 v[224:239], v[28:31], v[120:123], v[224:239]
    ds_read_b128 v[12:15], v5 offset:8192
    ds_read_b128 v[16:19], v5 offset:8704
    ds_read_b128 v[20:23], v5 offset:10240
    ds_read_b128 v[24:27], v5 offset:10752
    buffer_load_dwordx4 v[112:115], v4, s[16:19], s60 offen offset:0
    v_mfma_f32_32x32x16_bf16 v[240:255], v[32:35], v[120:123], v[240:255]
    buffer_load_dwordx4 v[116:119], v4, s[16:19], s60 offen offset:1024
    ds_write_b32 v7, v45 offset:4608
    v_cvt_pk_bf16_f32 v46, v134, v166
    ds_write_b32 v7, v46 offset:5120
    v_mfma_f32_32x32x16_bf16 v[224:239], v[36:39], v[124:127], v[224:239]
    v_cvt_pk_bf16_f32 v47, v135, v167
    ds_write_b32 v7, v47 offset:5632
    v_cvt_pk_bf16_f32 v44, v136, v168
    ds_write_b32 v7, v44 offset:8192
    v_mfma_f32_32x32x16_bf16 v[240:255], v[40:43], v[124:127], v[240:255]
    v_cvt_pk_bf16_f32 v45, v137, v169
    ds_write_b32 v7, v45 offset:8704
    v_cvt_pk_bf16_f32 v46, v138, v170
    ds_write_b32 v7, v46 offset:9216
    s_waitcnt vmcnt(16) lgkmcnt(0)
    v_mfma_f32_32x32x16_bf16 v[224:239], v[12:15], v[48:51], v[224:239]
    ds_read_b128 v[28:31], v5 offset:12288
    ds_read_b128 v[32:35], v5 offset:12800
    ds_read_b128 v[36:39], v5 offset:14336
    ds_read_b128 v[40:43], v5 offset:14848
    buffer_load_dwordx4 v[120:123], v4, s[16:19], s60 offen offset:2048
    v_mfma_f32_32x32x16_bf16 v[240:255], v[16:19], v[48:51], v[240:255]
    buffer_load_dwordx4 v[124:127], v4, s[16:19], s60 offen offset:3072
    s_add_u32 s60, s60, 4096
    v_cvt_pk_bf16_f32 v47, v139, v171
    ds_write_b32 v7, v47 offset:9728
    v_cvt_pk_bf16_f32 v44, v140, v172
    v_mfma_f32_32x32x16_bf16 v[224:239], v[20:23], v[52:55], v[224:239]
    ds_write_b32 v7, v44 offset:12288
    v_cvt_pk_bf16_f32 v45, v141, v173
    ds_write_b32 v7, v45 offset:12800
    v_cvt_pk_bf16_f32 v46, v142, v174
    v_mfma_f32_32x32x16_bf16 v[240:255], v[24:27], v[52:55], v[240:255]
    ds_write_b32 v7, v46 offset:13312
    v_cvt_pk_bf16_f32 v47, v143, v175
    ds_write_b32 v7, v47 offset:13824
    v_cvt_pk_bf16_f32 v44, v144, v176
    s_waitcnt vmcnt(16) lgkmcnt(0)
    v_mfma_f32_32x32x16_bf16 v[224:239], v[28:31], v[56:59], v[224:239]
    ds_read_b128 v[12:15], v5 offset:16384
    ds_read_b128 v[16:19], v5 offset:16896
    ds_read_b128 v[20:23], v5 offset:18432
    ds_read_b128 v[24:27], v5 offset:18944
    buffer_load_dwordx4 v[48:51], v4, s[16:19], s60 offen offset:0
    v_mfma_f32_32x32x16_bf16 v[240:255], v[32:35], v[56:59], v[240:255]
    buffer_load_dwordx4 v[52:55], v4, s[16:19], s60 offen offset:1024
    ds_write_b32 v7, v44 offset:16384
    v_cvt_pk_bf16_f32 v45, v145, v177
    ds_write_b32 v7, v45 offset:16896
    v_mfma_f32_32x32x16_bf16 v[224:239], v[36:39], v[60:63], v[224:239]
    v_cvt_pk_bf16_f32 v46, v146, v178
    ds_write_b32 v7, v46 offset:17408
    v_cvt_pk_bf16_f32 v47, v147, v179
    ds_write_b32 v7, v47 offset:17920
    v_mfma_f32_32x32x16_bf16 v[240:255], v[40:43], v[60:63], v[240:255]
    v_cvt_pk_bf16_f32 v44, v148, v180
    ds_write_b32 v7, v44 offset:20480
    v_cvt_pk_bf16_f32 v45, v149, v181
    ds_write_b32 v7, v45 offset:20992
    s_waitcnt vmcnt(16) lgkmcnt(0)
    v_mfma_f32_32x32x16_bf16 v[224:239], v[12:15], v[64:67], v[224:239]
    ds_read_b128 v[28:31], v5 offset:20480
    ds_read_b128 v[32:35], v5 offset:20992
    ds_read_b128 v[36:39], v5 offset:22528
    ds_read_b128 v[40:43], v5 offset:23040
    buffer_load_dwordx4 v[56:59], v4, s[16:19], s60 offen offset:2048
    v_mfma_f32_32x32x16_bf16 v[240:255], v[16:19], v[64:67], v[240:255]
    buffer_load_dwordx4 v[60:63], v4, s[16:19], s60 offen offset:3072
    s_add_u32 s60, s60, 4096
    v_cvt_pk_bf16_f32 v46, v150, v182
    ds_write_b32 v7, v46 offset:21504
    v_cvt_pk_bf16_f32 v47, v151, v183
    v_mfma_f32_32x32x16_bf16 v[224:239], v[20:23], v[68:71], v[224:239]
    ds_write_b32 v7, v47 offset:22016
    v_cvt_pk_bf16_f32 v44, v152, v184
    ds_write_b32 v7, v44 offset:24576
    v_cvt_pk_bf16_f32 v45, v153, v185
    v_mfma_f32_32x32x16_bf16 v[240:255], v[24:27], v[68:71], v[240:255]
    ds_write_b32 v7, v45 offset:25088
    v_cvt_pk_bf16_f32 v46, v154, v186
    ds_write_b32 v7, v46 offset:25600
    v_cvt_pk_bf16_f32 v47, v155, v187
    s_waitcnt vmcnt(16) lgkmcnt(0)
    v_mfma_f32_32x32x16_bf16 v[224:239], v[28:31], v[72:75], v[224:239]
    ds_read_b128 v[12:15], v5 offset:24576
    ds_read_b128 v[16:19], v5 offset:25088
    ds_read_b128 v[20:23], v5 offset:26624
    ds_read_b128 v[24:27], v5 offset:27136
    v_mfma_f32_32x32x16_bf16 v[240:255], v[32:35], v[72:75], v[240:255]
    buffer_load_dwordx4 v[64:67], v4, s[16:19], s60 offen offset:0
    buffer_load_dwordx4 v[68:71], v4, s[16:19], s60 offen offset:1024
    ds_write_b32 v7, v47 offset:26112
    v_cvt_pk_bf16_f32 v44, v156, v188
    v_mfma_f32_32x32x16_bf16 v[224:239], v[36:39], v[76:79], v[224:239]
    ds_write_b32 v7, v44 offset:28672
    v_cvt_pk_bf16_f32 v45, v157, v189
    ds_write_b32 v7, v45 offset:29184
    v_cvt_pk_bf16_f32 v46, v158, v190
    v_mfma_f32_32x32x16_bf16 v[240:255], v[40:43], v[76:79], v[240:255]
    ds_write_b32 v7, v46 offset:29696
    v_cvt_pk_bf16_f32 v47, v159, v191
    ds_write_b32 v7, v47 offset:30208
    s_waitcnt vmcnt(16) lgkmcnt(0)
    s_barrier
    v_mfma_f32_32x32x16_bf16 v[224:239], v[12:15], v[80:83], v[224:239]
    ds_read_b128 v[28:31], v5 offset:28672
    ds_read_b128 v[32:35], v5 offset:29184
    v_mfma_f32_32x32x16_bf16 v[240:255], v[16:19], v[80:83], v[240:255]
    ds_read_b128 v[36:39], v5 offset:30720
    ds_read_b128 v[40:43], v5 offset:31232
    v_mfma_f32_32x32x16_bf16 v[224:239], v[20:23], v[84:87], v[224:239]
    buffer_load_dwordx4 v[72:75], v4, s[16:19], s60 offen offset:2048
    buffer_load_dwordx4 v[76:79], v4, s[16:19], s60 offen offset:3072
    v_mfma_f32_32x32x16_bf16 v[240:255], v[24:27], v[84:87], v[240:255]
    s_add_u32 s60, s60, 4096
    s_waitcnt vmcnt(16) lgkmcnt(0)
    v_mfma_f32_32x32x16_bf16 v[224:239], v[28:31], v[88:91], v[224:239]
    ds_read_b128 v[12:15], v5 offset:32768
    v_mfma_f32_32x32x16_bf16 v[240:255], v[32:35], v[88:91], v[240:255]
    ds_read_b128 v[16:19], v5 offset:33280
    v_mfma_f32_32x32x16_bf16 v[224:239], v[36:39], v[92:95], v[224:239]
    ds_read_b128 v[20:23], v5 offset:34816
    v_mfma_f32_32x32x16_bf16 v[240:255], v[40:43], v[92:95], v[240:255]
    ds_read_b128 v[24:27], v5 offset:35328
    s_waitcnt vmcnt(14) lgkmcnt(0)
    v_mfma_f32_32x32x16_bf16 v[224:239], v[12:15], v[96:99], v[224:239]
    ds_read_b128 v[28:31], v5 offset:36864
    v_mfma_f32_32x32x16_bf16 v[240:255], v[16:19], v[96:99], v[240:255]
    ds_read_b128 v[32:35], v5 offset:37376
    v_mfma_f32_32x32x16_bf16 v[224:239], v[20:23], v[100:103], v[224:239]
    ds_read_b128 v[36:39], v5 offset:38912
    v_mfma_f32_32x32x16_bf16 v[240:255], v[24:27], v[100:103], v[240:255]
    ds_read_b128 v[40:43], v5 offset:39424
    s_waitcnt vmcnt(12) lgkmcnt(0)
    v_mfma_f32_32x32x16_bf16 v[224:239], v[28:31], v[104:107], v[224:239]
    ds_read_b128 v[12:15], v5 offset:40960
    v_mfma_f32_32x32x16_bf16 v[240:255], v[32:35], v[104:107], v[240:255]
    ds_read_b128 v[16:19], v5 offset:41472
    v_mfma_f32_32x32x16_bf16 v[224:239], v[36:39], v[108:111], v[224:239]
    ds_read_b128 v[20:23], v5 offset:43008
    v_mfma_f32_32x32x16_bf16 v[240:255], v[40:43], v[108:111], v[240:255]
    ds_read_b128 v[24:27], v5 offset:43520
    s_waitcnt vmcnt(10) lgkmcnt(0)
    v_mfma_f32_32x32x16_bf16 v[224:239], v[12:15], v[112:115], v[224:239]
    ds_read_b128 v[28:31], v5 offset:45056
    v_mfma_f32_32x32x16_bf16 v[240:255], v[16:19], v[112:115], v[240:255]
    ds_read_b128 v[32:35], v5 offset:45568
    v_mfma_f32_32x32x16_bf16 v[224:239], v[20:23], v[116:119], v[224:239]
    ds_read_b128 v[36:39], v5 offset:47104
    v_mfma_f32_32x32x16_bf16 v[240:255], v[24:27], v[116:119], v[240:255]
    ds_read_b128 v[40:43], v5 offset:47616
    s_waitcnt vmcnt(8) lgkmcnt(0)
    v_mfma_f32_32x32x16_bf16 v[224:239], v[28:31], v[120:123], v[224:239]
    ds_read_b128 v[12:15], v5 offset:49152
    v_mfma_f32_32x32x16_bf16 v[240:255], v[32:35], v[120:123], v[240:255]
    ds_read_b128 v[16:19], v5 offset:49664
    v_mfma_f32_32x32x16_bf16 v[224:239], v[36:39], v[124:127], v[224:239]
    ds_read_b128 v[20:23], v5 offset:51200
    v_mfma_f32_32x32x16_bf16 v[240:255], v[40:43], v[124:127], v[240:255]
    ds_read_b128 v[24:27], v5 offset:51712
    s_waitcnt vmcnt(6) lgkmcnt(0)
    v_mfma_f32_32x32x16_bf16 v[224:239], v[12:15], v[48:51], v[224:239]
    ds_read_b128 v[28:31], v5 offset:53248
    v_mfma_f32_32x32x16_bf16 v[240:255], v[16:19], v[48:51], v[240:255]
    ds_read_b128 v[32:35], v5 offset:53760
    v_mfma_f32_32x32x16_bf16 v[224:239], v[20:23], v[52:55], v[224:239]
    ds_read_b128 v[36:39], v5 offset:55296
    v_mfma_f32_32x32x16_bf16 v[240:255], v[24:27], v[52:55], v[240:255]
    ds_read_b128 v[40:43], v5 offset:55808
    s_waitcnt vmcnt(4) lgkmcnt(0)
    v_mfma_f32_32x32x16_bf16 v[224:239], v[28:31], v[56:59], v[224:239]
    ds_read_b128 v[12:15], v5 offset:57344
    v_mfma_f32_32x32x16_bf16 v[240:255], v[32:35], v[56:59], v[240:255]
    ds_read_b128 v[16:19], v5 offset:57856
    v_mfma_f32_32x32x16_bf16 v[224:239], v[36:39], v[60:63], v[224:239]
    ds_read_b128 v[20:23], v5 offset:59392
    v_mfma_f32_32x32x16_bf16 v[240:255], v[40:43], v[60:63], v[240:255]
    ds_read_b128 v[24:27], v5 offset:59904
    s_waitcnt vmcnt(2) lgkmcnt(0)
    v_mfma_f32_32x32x16_bf16 v[224:239], v[12:15], v[64:67], v[224:239]
    ds_read_b128 v[28:31], v5 offset:61440
    v_mfma_f32_32x32x16_bf16 v[240:255], v[16:19], v[64:67], v[240:255]
    ds_read_b128 v[32:35], v5 offset:61952
    v_mfma_f32_32x32x16_bf16 v[224:239], v[20:23], v[68:71], v[224:239]
    ds_read_b128 v[36:39], v5 offset:63488
    v_mfma_f32_32x32x16_bf16 v[240:255], v[24:27], v[68:71], v[240:255]
    ds_read_b128 v[40:43], v5 offset:64000
    s_waitcnt vmcnt(0) lgkmcnt(0)
    v_mfma_f32_32x32x16_bf16 v[224:239], v[28:31], v[72:75], v[224:239]
    v_mfma_f32_32x32x16_bf16 v[240:255], v[32:35], v[72:75], v[240:255]
    v_mfma_f32_32x32x16_bf16 v[224:239], v[36:39], v[76:79], v[224:239]
    v_mfma_f32_32x32x16_bf16 v[240:255], v[40:43], v[76:79], v[240:255]
    s_nop 7
    s_nop 7
    v_cvt_pk_bf16_f32 v44, v192, v224
    ds_write_b32 v7, v44 offset:32768
    v_cvt_pk_bf16_f32 v45, v193, v225
    ds_write_b32 v7, v45 offset:33280
    v_cvt_pk_bf16_f32 v46, v194, v226
    ds_write_b32 v7, v46 offset:33792
    v_cvt_pk_bf16_f32 v47, v195, v227
    ds_write_b32 v7, v47 offset:34304
    v_cvt_pk_bf16_f32 v44, v196, v228
    ds_write_b32 v7, v44 offset:36864
    v_cvt_pk_bf16_f32 v45, v197, v229
    ds_write_b32 v7, v45 offset:37376
    v_cvt_pk_bf16_f32 v46, v198, v230
    ds_write_b32 v7, v46 offset:37888
    v_cvt_pk_bf16_f32 v47, v199, v231
    ds_write_b32 v7, v47 offset:38400
    v_cvt_pk_bf16_f32 v44, v200, v232
    ds_write_b32 v7, v44 offset:40960
    v_cvt_pk_bf16_f32 v45, v201, v233
    ds_write_b32 v7, v45 offset:41472
    v_cvt_pk_bf16_f32 v46, v202, v234
    ds_write_b32 v7, v46 offset:41984
    v_cvt_pk_bf16_f32 v47, v203, v235
    ds_write_b32 v7, v47 offset:42496
    v_cvt_pk_bf16_f32 v44, v204, v236
    ds_write_b32 v7, v44 offset:45056
    v_cvt_pk_bf16_f32 v45, v205, v237
    ds_write_b32 v7, v45 offset:45568
    v_cvt_pk_bf16_f32 v46, v206, v238
    ds_write_b32 v7, v46 offset:46080
    v_cvt_pk_bf16_f32 v47, v207, v239
    ds_write_b32 v7, v47 offset:46592
    v_cvt_pk_bf16_f32 v44, v208, v240
    ds_write_b32 v7, v44 offset:49152
    v_cvt_pk_bf16_f32 v45, v209, v241
    ds_write_b32 v7, v45 offset:49664
    v_cvt_pk_bf16_f32 v46, v210, v242
    ds_write_b32 v7, v46 offset:50176
    v_cvt_pk_bf16_f32 v47, v211, v243
    ds_write_b32 v7, v47 offset:50688
    v_cvt_pk_bf16_f32 v44, v212, v244
    ds_write_b32 v7, v44 offset:53248
    v_cvt_pk_bf16_f32 v45, v213, v245
    ds_write_b32 v7, v45 offset:53760
    v_cvt_pk_bf16_f32 v46, v214, v246
    ds_write_b32 v7, v46 offset:54272
    v_cvt_pk_bf16_f32 v47, v215, v247
    ds_write_b32 v7, v47 offset:54784
    v_cvt_pk_bf16_f32 v44, v216, v248
    ds_write_b32 v7, v44 offset:57344
    v_cvt_pk_bf16_f32 v45, v217, v249
    ds_write_b32 v7, v45 offset:57856
    v_cvt_pk_bf16_f32 v46, v218, v250
    ds_write_b32 v7, v46 offset:58368
    v_cvt_pk_bf16_f32 v47, v219, v251
    ds_write_b32 v7, v47 offset:58880
    v_cvt_pk_bf16_f32 v44, v220, v252
    ds_write_b32 v7, v44 offset:61440
    v_cvt_pk_bf16_f32 v45, v221, v253
    ds_write_b32 v7, v45 offset:61952
    v_cvt_pk_bf16_f32 v46, v222, v254
    ds_write_b32 v7, v46 offset:62464
    v_cvt_pk_bf16_f32 v47, v223, v255
    ds_write_b32 v7, v47 offset:62976
    s_waitcnt lgkmcnt(0)
    v_lshrrev_b32 v2, 5, v0
    v_and_b32 v3, 31, v0
    s_lshl_b32 s56, s54, 12
    s_add_u32 s56, s56, 131072
    v_lshl_add_u32 v4, v0, 4, s56
    v_lshrrev_b32 v5, 3, v3
    v_lshlrev_b32 v5, 8, v5
    v_and_b32 v6, 7, v3
    v_lshl_add_u32 v5, v6, 4, v5
    v_lshl_add_u32 v5, v2, 10, v5
    s_mul_i32 s56, s50, 1000
    s_mul_i32 s57, s51, 250
    s_add_u32 s56, s56, s57
    s_lshl_b32 s57, s49, 3
    s_add_u32 s56, s56, s57
    s_lshl_b32 s56, s56, 13
    s_lshl_b32 s58, s54, 13
    s_add_u32 s56, s56, s58
    s_add_u32 s56, s56, 128
    s_sub_u32 s59, 250, s57
    s_lshl_b32 s59, s59, 3
    s_lshl_b32 s58, s54, 3
    s_cmp_gt_u32 s59, s58
    s_cselect_b32 s58, 0, 0x80000000
    v_add_u32 v5, s56, v5
    v_or_b32 v5, s58, v5
    s_barrier
    ds_read_b128 v[16:19], v4 offset:0
    ds_read_b128 v[20:23], v4 offset:1024
    ds_read_b128 v[24:27], v4 offset:2048
    ds_read_b128 v[28:31], v4 offset:3072
    s_waitcnt lgkmcnt(3)
    s_mov_b32 s56, 0
    buffer_store_dwordx4 v[16:19], v5, s[20:23], s56 offen nt
    s_waitcnt lgkmcnt(2)
    s_mov_b32 s56, 2048
    buffer_store_dwordx4 v[20:23], v5, s[20:23], s56 offen nt
    s_waitcnt lgkmcnt(1)
    s_mov_b32 s56, 4096
    buffer_store_dwordx4 v[24:27], v5, s[20:23], s56 offen nt
    s_waitcnt lgkmcnt(0)
    s_mov_b32 s56, 6144
    buffer_store_dwordx4 v[28:31], v5, s[20:23], s56 offen nt
    s_branch L_fin
L_Lwaves:
    v_lshrrev_b32 v4, 3, v0
    v_lshrrev_b32 v5, 1, v4
    v_and_b32 v5, 1, v5
    s_and_b32 s56, s55, 1
    s_lshl_b32 s56, s56, 1
    v_or_b32 v5, s56, v5
    v_lshlrev_b32 v5, 1, v5
    v_and_b32 v6, 7, v0
    v_xor_b32 v6, v6, v5
    v_lshlrev_b32 v6, 4, v6
    s_lshl_b32 s56, s55, 3
    v_add_u32 v4, s56, v4
    v_lshl_add_u32 v18, v4, 10, v6
    s_mov_b32 s77, 0
    s_mov_b32 s78, 0
    s_add_u32 s3, s52, s53
    s_and_b32 s3, s3, 1
    s_lshl_b32 s4, s3, 16
    s_lshl_b32 s3, s3, 7
    s_lshl_b32 s56, s53, 7
    s_add_u32 s4, s4, s56
    s_lshl_b32 s56, s55, 10
    s_add_u32 s56, s56, s78
    s_xor_b32 s57, s4, 0
    s_add_u32 m0, s56, 101376
    s_nop 0
    buffer_load_dwordx4 v18, s[12:15], s57 offen lds
    s_add_u32 m0, s56, 105472
    s_add_u32 s57, s57, 524288
    buffer_load_dwordx4 v18, s[12:15], s57 offen lds
    s_add_u32 m0, s56, 109568
    s_add_u32 s57, s57, 524288
    buffer_load_dwordx4 v18, s[12:15], s57 offen lds
    s_add_u32 m0, s56, 113664
    s_add_u32 s57, s57, 524288
    buffer_load_dwordx4 v18, s[12:15], s57 offen lds
    s_add_u32 m0, s56, 117760
    s_add_u32 s57, s57, 524288
    buffer_load_dwordx4 v18, s[12:15], s57 offen lds
    s_add_u32 s78, s78, 20480
    s_cmp_ge_u32 s78, 61440
    s_cselect_b32 s78, 0, s78
    s_mul_i32 s64, s51, 1000
    s_lshl_b32 s65, s52, 8
    s_add_u32 s64, s64, s65
    s_sub_u32 s64, s64, 6
    s_xor_b32 s82, s3, 0
    s_lshl_b32 s60, s55, 10
    v_lshrrev_b32 v2, 3, v0
    v_and_b32 v3, 7, v0
    s_lshl_b32 s56, s55, 3
    s_mov_b32 s57, 1986
    s_mov_b32 s58, 0x42764210
    v_mov_b32 v7, 0x80000000
    v_add_u32 v4, s56, v2
    v_mul_u32_u24 v5, s57, v4
    v_lshrrev_b32 v5, 16, v5
    v_mul_u32_u24 v6, 33, v5
    v_sub_u32 v6, v4, v6
    v_and_b32 v20, 3, v5
    v_lshl_add_u32 v20, v6, 2, v20
    v_lshrrev_b32 v21, 2, v5
    v_lshl_add_u32 v20, v20, 1, v21
    v_add_u32 v20, s64, v20
    v_subrev_u32 v22, 0, v20
    v_cmp_gt_u32 vcc, 4000, v22
    v_lshlrev_b32 v21, 1, v6
    v_and_b32 v21, 28, v21
    v_lshrrev_b32 v21, v21, s58
    v_and_b32 v21, 7, v21
    v_xor_b32 v21, v21, v3
    v_lshlrev_b32 v21, 4, v21
    v_lshl_add_u32 v21, v20, 10, v21
    v_cndmask_b32 v8, v7, v21, vcc
    s_add_u32 m0, s60, 0
    s_nop 0
    buffer_load_dwordx4 v8, s[8:11], s82 offen  lds
    v_add_u32 v4, 32, v4
    v_mul_u32_u24 v5, s57, v4
    v_lshrrev_b32 v5, 16, v5
    v_mul_u32_u24 v6, 33, v5
    v_sub_u32 v6, v4, v6
    v_and_b32 v20, 3, v5
    v_lshl_add_u32 v20, v6, 2, v20
    v_lshrrev_b32 v21, 2, v5
    v_lshl_add_u32 v20, v20, 1, v21
    v_add_u32 v20, s64, v20
    v_subrev_u32 v22, 0, v20
    v_cmp_gt_u32 vcc, 4000, v22
    v_lshlrev_b32 v21, 1, v6
    v_and_b32 v21, 28, v21
    v_lshrrev_b32 v21, v21, s58
    v_and_b32 v21, 7, v21
    v_xor_b32 v21, v21, v3
    v_lshlrev_b32 v21, 4, v21
    v_lshl_add_u32 v21, v20, 10, v21
    v_cndmask_b32 v9, v7, v21, vcc
    s_add_u32 m0, s60, 4096
    s_nop 0
    buffer_load_dwordx4 v9, s[8:11], s82 offen  lds
    v_add_u32 v4, 32, v4
    v_mul_u32_u24 v5, s57, v4
    v_lshrrev_b32 v5, 16, v5
    v_mul_u32_u24 v6, 33, v5
    v_sub_u32 v6, v4, v6
    v_and_b32 v20, 3, v5
    v_lshl_add_u32 v20, v6, 2, v20
    v_lshrrev_b32 v21, 2, v5
    v_lshl_add_u32 v20, v20, 1, v21
    v_add_u32 v20, s64, v20
    v_subrev_u32 v22, 0, v20
    v_cmp_gt_u32 vcc, 4000, v22
    v_lshlrev_b32 v21, 1, v6
    v_and_b32 v21, 28, v21
    v_lshrrev_b32 v21, v21, s58
    v_and_b32 v21, 7, v21
    v_xor_b32 v21, v21, v3
    v_lshlrev_b32 v21, 4, v21
    v_lshl_add_u32 v21, v20, 10, v21
    v_cndmask_b32 v10, v7, v21, vcc
    s_add_u32 m0, s60, 8192
    s_nop 0
    buffer_load_dwordx4 v10, s[8:11], s82 offen  lds
    v_add_u32 v4, 32, v4
    v_mul_u32_u24 v5, s57, v4
    v_lshrrev_b32 v5, 16, v5
    v_mul_u32_u24 v6, 33, v5
    v_sub_u32 v6, v4, v6
    v_and_b32 v20, 3, v5
    v_lshl_add_u32 v20, v6, 2, v20
    v_lshrrev_b32 v21, 2, v5
    v_lshl_add_u32 v20, v20, 1, v21
    v_add_u32 v20, s64, v20
    v_subrev_u32 v22, 0, v20
    v_cmp_gt_u32 vcc, 4000, v22
    v_lshlrev_b32 v21, 1, v6
    v_and_b32 v21, 28, v21
    v_lshrrev_b32 v21, v21, s58
    v_and_b32 v21, 7, v21
    v_xor_b32 v21, v21, v3
    v_lshlrev_b32 v21, 4, v21
    v_lshl_add_u32 v21, v20, 10, v21
    v_cndmask_b32 v11, v7, v21, vcc
    s_add_u32 m0, s60, 12288
    s_nop 0
    buffer_load_dwordx4 v11, s[8:11], s82 offen  lds
    v_add_u32 v4, 32, v4
    v_mul_u32_u24 v5, s57, v4
    v_lshrrev_b32 v5, 16, v5
    v_mul_u32_u24 v6, 33, v5
    v_sub_u32 v6, v4, v6
    v_and_b32 v20, 3, v5
    v_lshl_add_u32 v20, v6, 2, v20
    v_lshrrev_b32 v21, 2, v5
    v_lshl_add_u32 v20, v20, 1, v21
    v_add_u32 v20, s64, v20
    v_subrev_u32 v22, 0, v20
    v_cmp_gt_u32 vcc, 4000, v22
    v_lshlrev_b32 v21, 1, v6
    v_and_b32 v21, 28, v21
    v_lshrrev_b32 v21, v21, s58
    v_and_b32 v21, 7, v21
    v_xor_b32 v21, v21, v3
    v_lshlrev_b32 v21, 4, v21
    v_lshl_add_u32 v21, v20, 10, v21
    v_cndmask_b32 v12, v7, v21, vcc
    s_add_u32 m0, s60, 16384
    s_nop 0
    buffer_load_dwordx4 v12, s[8:11], s82 offen  lds
    v_add_u32 v4, 32, v4
    v_mul_u32_u24 v5, s57, v4
    v_lshrrev_b32 v5, 16, v5
    v_mul_u32_u24 v6, 33, v5
    v_sub_u32 v6, v4, v6
    v_and_b32 v20, 3, v5
    v_lshl_add_u32 v20, v6, 2, v20
    v_lshrrev_b32 v21, 2, v5
    v_lshl_add_u32 v20, v20, 1, v21
    v_add_u32 v20, s64, v20
    v_subrev_u32 v22, 0, v20
    v_cmp_gt_u32 vcc, 4000, v22
    v_lshlrev_b32 v21, 1, v6
    v_and_b32 v21, 28, v21
    v_lshrrev_b32 v21, v21, s58
    v_and_b32 v21, 7, v21
    v_xor_b32 v21, v21, v3
    v_lshlrev_b32 v21, 4, v21
    v_lshl_add_u32 v21, v20, 10, v21
    v_cndmask_b32 v13, v7, v21, vcc
    s_add_u32 m0, s60, 20480
    s_nop 0
    buffer_load_dwordx4 v13, s[8:11], s82 offen  lds
    v_add_u32 v4, 32, v4
    v_mul_u32_u24 v5, s57, v4
    v_lshrrev_b32 v5, 16, v5
    v_mul_u32_u24 v6, 33, v5
    v_sub_u32 v6, v4, v6
    v_and_b32 v20, 3, v5
    v_lshl_add_u32 v20, v6, 2, v20
    v_lshrrev_b32 v21, 2, v5
    v_lshl_add_u32 v20, v20, 1, v21
    v_add_u32 v20, s64, v20
    v_subrev_u32 v22, 0, v20
    v_cmp_gt_u32 vcc, 4000, v22
    v_lshlrev_b32 v21, 1, v6
    v_and_b32 v21, 28, v21
    v_lshrrev_b32 v21, v21, s58
    v_and_b32 v21, 7, v21
    v_xor_b32 v21, v21, v3
    v_lshlrev_b32 v21, 4, v21
    v_lshl_add_u32 v21, v20, 10, v21
    v_cndmask_b32 v14, v7, v21, vcc
    s_add_u32 m0, s60, 24576
    s_nop 0
    buffer_load_dwordx4 v14, s[8:11], s82 offen  lds
    v_add_u32 v4, 32, v4
    v_mul_u32_u24 v5, s57, v4
    v_lshrrev_b32 v5, 16, v5
    v_mul_u32_u24 v6, 33, v5
    v_sub_u32 v6, v4, v6
    v_and_b32 v20, 3, v5
    v_lshl_add_u32 v20, v6, 2, v20
    v_lshrrev_b32 v21, 2, v5
    v_lshl_add_u32 v20, v20, 1, v21
    v_add_u32 v20, s64, v20
    v_subrev_u32 v22, 0, v20
    v_cmp_gt_u32 vcc, 4000, v22
    v_lshlrev_b32 v21, 1, v6
    v_and_b32 v21, 28, v21
    v_lshrrev_b32 v21, v21, s58
    v_and_b32 v21, 7, v21
    v_xor_b32 v21, v21, v3
    v_lshlrev_b32 v21, 4, v21
    v_lshl_add_u32 v21, v20, 10, v21
    v_cndmask_b32 v15, v7, v21, vcc
    s_add_u32 m0, s60, 28672
    s_nop 0
    buffer_load_dwordx4 v15, s[8:11], s82 offen  lds
    v_add_u32 v4, 32, v4
    v_mul_u32_u24 v5, s57, v4
    v_lshrrev_b32 v5, 16, v5
    v_mul_u32_u24 v6, 33, v5
    v_sub_u32 v6, v4, v6
    v_and_b32 v20, 3, v5
    v_lshl_add_u32 v20, v6, 2, v20
    v_lshrrev_b32 v21, 2, v5
    v_lshl_add_u32 v20, v20, 1, v21
    v_add_u32 v20, s64, v20
    v_subrev_u32 v22, 0, v20
    v_cmp_gt_u32 vcc, 4000, v22
    v_lshlrev_b32 v21, 1, v6
    v_and_b32 v21, 28, v21
    v_lshrrev_b32 v21, v21, s58
    v_and_b32 v21, 7, v21
    v_xor_b32 v21, v21, v3
    v_lshlrev_b32 v21, 4, v21
    v_lshl_add_u32 v21, v20, 10, v21
    v_cndmask_b32 v16, v7, v21, vcc
    v_cmp_gt_u32 vcc, 264, v4
    s_nop 1
    v_cndmask_b32 v16, v7, v16, vcc
    s_cmp_lt_u32 s55, 1
    s_cbranch_scc0 Lx_39
    s_add_u32 m0, s60, 32768
    s_nop 0
    buffer_load_dwordx4 v16, s[8:11], s82 offen  lds
Lx_39:
    s_mov_b32 s77, 33792
    s_barrier
    s_lshl_b32 s56, s55, 10
    s_add_u32 s56, s56, s78
    s_xor_b32 s57, s4, 32768
    s_add_u32 m0, s56, 101376
    s_nop 0
    buffer_load_dwordx4 v18, s[12:15], s57 offen lds
    s_add_u32 m0, s56, 105472
    s_add_u32 s57, s57, 524288
    buffer_load_dwordx4 v18, s[12:15], s57 offen lds
    s_add_u32 m0, s56, 109568
    s_add_u32 s57, s57, 524288
    buffer_load_dwordx4 v18, s[12:15], s57 offen lds
    s_add_u32 m0, s56, 113664
    s_add_u32 s57, s57, 524288
    buffer_load_dwordx4 v18, s[12:15], s57 offen lds
    s_add_u32 m0, s56, 117760
    s_add_u32 s57, s57, 524288
    buffer_load_dwordx4 v18, s[12:15], s57 offen lds
    s_add_u32 s78, s78, 20480
    s_cmp_ge_u32 s78, 61440
    s_cselect_b32 s78, 0, s78
    s_waitcnt vmcnt(5)
    s_barrier
    s_xor_b32 s82, s3, 128
    s_lshl_b32 s56, s55, 10
    s_add_u32 s56, s56, s77
    s_add_u32 m0, s56, 0
    s_nop 0
    buffer_load_dwordx4 v8, s[8:11], s82 offen  lds
    s_add_u32 m0, s56, 4096
    s_nop 0
    buffer_load_dwordx4 v9, s[8:11], s82 offen  lds
    s_add_u32 m0, s56, 8192
    s_nop 0
    buffer_load_dwordx4 v10, s[8:11], s82 offen  lds
    s_add_u32 m0, s56, 12288
    s_nop 0
    buffer_load_dwordx4 v11, s[8:11], s82 offen  lds
    s_add_u32 m0, s56, 16384
    s_nop 0
    buffer_load_dwordx4 v12, s[8:11], s82 offen  lds
    s_add_u32 m0, s56, 20480
    s_nop 0
    buffer_load_dwordx4 v13, s[8:11], s82 offen  lds
    s_add_u32 m0, s56, 24576
    s_nop 0
    buffer_load_dwordx4 v14, s[8:11], s82 offen  lds
    s_add_u32 m0, s56, 28672
    s_nop 0
    buffer_load_dwordx4 v15, s[8:11], s82 offen  lds
    s_cmp_lt_u32 s55, 1
    s_cbranch_scc0 Lx_40
    s_add_u32 m0, s56, 32768
    s_nop 0
    buffer_load_dwordx4 v16, s[8:11], s82 offen  lds
Lx_40:
    s_add_u32 s77, s77, 33792
    s_cmp_ge_u32 s77, 101376
    s_cselect_b32 s56, 101376, 0
    s_sub_u32 s77, s77, s56
    s_lshl_b32 s56, s55, 10
    s_add_u32 s56, s56, s78
    s_xor_b32 s57, s4, 65536
    s_add_u32 m0, s56, 101376
    s_nop 0
    buffer_load_dwordx4 v18, s[12:15], s57 offen lds
    s_add_u32 m0, s56, 105472
    s_add_u32 s57, s57, 524288
    buffer_load_dwordx4 v18, s[12:15], s57 offen lds
    s_add_u32 m0, s56, 109568
    s_add_u32 s57, s57, 524288
    buffer_load_dwordx4 v18, s[12:15], s57 offen lds
    s_add_u32 m0, s56, 113664
    s_add_u32 s57, s57, 524288
    buffer_load_dwordx4 v18, s[12:15], s57 offen lds
    s_add_u32 m0, s56, 117760
    s_add_u32 s57, s57, 524288
    buffer_load_dwordx4 v18, s[12:15], s57 offen lds
    s_add_u32 s78, s78, 20480
    s_cmp_ge_u32 s78, 61440
    s_cselect_b32 s78, 0, s78
    s_xor_b32 s82, s3, 256
    s_lshl_b32 s56, s55, 10
    s_add_u32 s56, s56, s77
    s_add_u32 m0, s56, 0
    s_nop 0
    buffer_load_dwordx4 v8, s[8:11], s82 offen  lds
    s_add_u32 m0, s56, 4096
    s_nop 0
    buffer_load_dwordx4 v9, s[8:11], s82 offen  lds
    s_add_u32 m0, s56, 8192
    s_nop 0
    buffer_load_dwordx4 v10, s[8:11], s82 offen  lds
    s_add_u32 m0, s56, 12288
    s_nop 0
    buffer_load_dwordx4 v11, s[8:11], s82 offen  lds
    s_add_u32 m0, s56, 16384
    s_nop 0
    buffer_load_dwordx4 v12, s[8:11], s82 offen  lds
    s_waitcnt vmcnt(18)
    s_barrier
    s_lshl_b32 s56, s55, 10
    s_add_u32 s56, s56, s78
    s_xor_b32 s57, s4, 98304
    s_add_u32 m0, s56, 101376
    s_nop 0
    buffer_load_dwordx4 v18, s[12:15], s57 offen lds
    s_add_u32 m0, s56, 105472
    s_add_u32 s57, s57, 524288
    buffer_load_dwordx4 v18, s[12:15], s57 offen lds
    s_add_u32 m0, s56, 109568
    s_add_u32 s57, s57, 524288
    buffer_load_dwordx4 v18, s[12:15], s57 offen lds
    s_add_u32 m0, s56, 113664
    s_add_u32 s57, s57, 524288
    buffer_load_dwordx4 v18, s[12:15], s57 offen lds
    s_add_u32 m0, s56, 117760
    s_add_u32 s57, s57, 524288
    buffer_load_dwordx4 v18, s[12:15], s57 offen lds
    s_add_u32 s78, s78, 20480
    s_cmp_ge_u32 s78, 61440
    s_cselect_b32 s78, 0, s78
    s_xor_b32 s82, s3, 256
    s_lshl_b32 s56, s55, 10
    s_add_u32 s56, s56, s77
    s_add_u32 m0, s56, 20480
    s_nop 0
    buffer_load_dwordx4 v13, s[8:11], s82 offen  lds
    s_add_u32 m0, s56, 24576
    s_nop 0
    buffer_load_dwordx4 v14, s[8:11], s82 offen  lds
    s_add_u32 m0, s56, 28672
    s_nop 0
    buffer_load_dwordx4 v15, s[8:11], s82 offen  lds
    s_cmp_lt_u32 s55, 1
    s_cbranch_scc0 Lx_41
    s_add_u32 m0, s56, 32768
    s_nop 0
    buffer_load_dwordx4 v16, s[8:11], s82 offen  lds
Lx_41:
    s_add_u32 s77, s77, 33792
    s_cmp_ge_u32 s77, 101376
    s_cselect_b32 s56, 101376, 0
    s_sub_u32 s77, s77, s56
    s_waitcnt vmcnt(13)
    s_barrier
    s_lshl_b32 s56, s55, 10
    s_add_u32 s56, s56, s78
    s_xor_b32 s57, s4, 131072
    s_add_u32 m0, s56, 101376
    s_nop 0
    buffer_load_dwordx4 v18, s[12:15], s57 offen lds
    s_add_u32 m0, s56, 105472
    s_add_u32 s57, s57, 524288
    buffer_load_dwordx4 v18, s[12:15], s57 offen lds
    s_add_u32 m0, s56, 109568
    s_add_u32 s57, s57, 524288
    buffer_load_dwordx4 v18, s[12:15], s57 offen lds
    s_add_u32 m0, s56, 113664
    s_add_u32 s57, s57, 524288
    buffer_load_dwordx4 v18, s[12:15], s57 offen lds
    s_add_u32 m0, s56, 117760
    s_add_u32 s57, s57, 524288
    buffer_load_dwordx4 v18, s[12:15], s57 offen lds
    s_add_u32 s78, s78, 20480
    s_cmp_ge_u32 s78, 61440
    s_cselect_b32 s78, 0, s78
    s_xor_b32 s82, s3, 384
    s_lshl_b32 s56, s55, 10
    s_add_u32 s56, s56, s77
    s_add_u32 m0, s56, 0
    s_nop 0
    buffer_load_dwordx4 v8, s[8:11], s82 offen  lds
    s_add_u32 m0, s56, 4096
    s_nop 0
    buffer_load_dwordx4 v9, s[8:11], s82 offen  lds
    s_add_u32 m0, s56, 8192
    s_nop 0
    buffer_load_dwordx4 v10, s[8:11], s82 offen  lds
    s_add_u32 m0, s56, 12288
    s_nop 0
    buffer_load_dwordx4 v11, s[8:11], s82 offen  lds
    s_add_u32 m0, s56, 16384
    s_nop 0
    buffer_load_dwordx4 v12, s[8:11], s82 offen  lds
    s_cmp_eq_u32 s55, 3
    s_cbranch_scc0 Lo_42
    v_lshrrev_b32 v2, 3, v0
    v_lshlrev_b32 v2, 19, v2
    v_and_b32 v3, 7, v0
    v_lshl_add_u32 v2, v3, 15, v2
    s_lshl_b32 s56, s49, 10
    s_add_u32 s56, s56, 262528
    v_add_u32 v2, s56, v2
    v_cmp_gt_u32 vcc, 40, v0
    v_mov_b32 v3, 0x80000000
    s_nop 0
    v_cndmask_b32 v2, v3, v2, vcc
    buffer_load_dword v208, v2, s[12:15], 0 offen
Lo_42:
    s_waitcnt vmcnt(13)
    s_barrier
    s_lshl_b32 s56, s55, 10
    s_add_u32 s56, s56, s78
    s_xor_b32 s57, s4, 163840
    s_add_u32 m0, s56, 101376
    s_nop 0
    buffer_load_dwordx4 v18, s[12:15], s57 offen lds
    s_add_u32 m0, s56, 105472
    s_add_u32 s57, s57, 524288
    buffer_load_dwordx4 v18, s[12:15], s57 offen lds
    s_add_u32 m0, s56, 109568
    s_add_u32 s57, s57, 524288
    buffer_load_dwordx4 v18, s[12:15], s57 offen lds
    s_add_u32 m0, s56, 113664
    s_add_u32 s57, s57, 524288
    buffer_load_dwordx4 v18, s[12:15], s57 offen lds
    s_add_u32 m0, s56, 117760
    s_add_u32 s57, s57, 524288
    buffer_load_dwordx4 v18, s[12:15], s57 offen lds
    s_add_u32 s78, s78, 20480
    s_cmp_ge_u32 s78, 61440
    s_cselect_b32 s78, 0, s78
    s_xor_b32 s82, s3, 384
    s_lshl_b32 s56, s55, 10
    s_add_u32 s56, s56, s77
    s_add_u32 m0, s56, 20480
    s_nop 0
    buffer_load_dwordx4 v13, s[8:11], s82 offen  lds
    s_add_u32 m0, s56, 24576
    s_nop 0
    buffer_load_dwordx4 v14, s[8:11], s82 offen  lds
    s_add_u32 m0, s56, 28672
    s_nop 0
    buffer_load_dwordx4 v15, s[8:11], s82 offen  lds
    s_cmp_lt_u32 s55, 1
    s_cbranch_scc0 Lx_43
    s_add_u32 m0, s56, 32768
    s_nop 0
    buffer_load_dwordx4 v16, s[8:11], s82 offen  lds
Lx_43:
    s_add_u32 s77, s77, 33792
    s_cmp_ge_u32 s77, 101376
    s_cselect_b32 s56, 101376, 0
    s_sub_u32 s77, s77, s56
    s_mov_b32 s24, s32
    s_and_b32 s25, s33, 0xffff
    s_mov_b32 s26, 0x280000
    s_mov_b32 s27, 0x20000
    s_mul_i32 s58, s2, 12288
    s_mul_i32 s59, s55, 3072
    s_add_u32 s58, s58, s59
    v_lshl_add_u32 v4, v0, 4, s58
    buffer_load_dwordx4 v[200:203], v4, s[24:27], 0 offen offset:0
    buffer_load_dwordx4 v[200:203], v4, s[24:27], 0 offen offset:1024
    buffer_load_dwordx4 v[200:203], v4, s[24:27], 0 offen offset:2048
    s_mov_b32 s24, s38
    s_and_b32 s25, s39, 0xffff
    s_mov_b32 s26, 0x80000
    s_mov_b32 s27, 0x20000
    s_lshl_b32 s58, s2, 11
    s_lshl_b32 s59, s55, 9
    s_add_u32 s58, s58, s59
    v_and_b32 v4, 31, v0
    v_lshl_add_u32 v4, v4, 4, s58
    buffer_load_dwordx4 v[200:203], v4, s[24:27], 0 offen
    s_waitcnt vmcnt(17)
    s_barrier
    s_lshl_b32 s56, s55, 10
    s_add_u32 s56, s56, s78
    s_xor_b32 s57, s4, 196608
    s_add_u32 m0, s56, 101376
    s_nop 0
    buffer_load_dwordx4 v18, s[12:15], s57 offen lds
    s_add_u32 m0, s56, 105472
    s_add_u32 s57, s57, 524288
    buffer_load_dwordx4 v18, s[12:15], s57 offen lds
    s_add_u32 m0, s56, 109568
    s_add_u32 s57, s57, 524288
    buffer_load_dwordx4 v18, s[12:15], s57 offen lds
    s_add_u32 m0, s56, 113664
    s_add_u32 s57, s57, 524288
    buffer_load_dwordx4 v18, s[12:15], s57 offen lds
    s_add_u32 m0, s56, 117760
    s_add_u32 s57, s57, 524288
    buffer_load_dwordx4 v18, s[12:15], s57 offen lds
    s_add_u32 s78, s78, 20480
    s_cmp_ge_u32 s78, 61440
    s_cselect_b32 s78, 0, s78
    s_xor_b32 s82, s3, 512
    s_lshl_b32 s56, s55, 10
    s_add_u32 s56, s56, s77
    s_add_u32 m0, s56, 0
    s_nop 0
    buffer_load_dwordx4 v8, s[8:11], s82 offen  lds
    s_add_u32 m0, s56, 4096
    s_nop 0
    buffer_load_dwordx4 v9, s[8:11], s82 offen  lds
    s_add_u32 m0, s56, 8192
    s_nop 0
    buffer_load_dwordx4 v10, s[8:11], s82 offen  lds
    s_add_u32 m0, s56, 12288
    s_nop 0
    buffer_load_dwordx4 v11, s[8:11], s82 offen  lds
    s_add_u32 m0, s56, 16384
    s_nop 0
    buffer_load_dwordx4 v12, s[8:11], s82 offen  lds
    v_mov_b32 v2, 163584
    ds_read_b32 v3, v2
    s_waitcnt lgkmcnt(0)
    v_readfirstlane_b32 s86, v3
    s_lshl_b32 s57, s48, 8
    s_add_u32 s57, s57, 15929344
    v_and_b32 v28, 31, v0
    v_lshlrev_b32 v28, 3, v28
    v_add_u32 v28, s57, v28
    s_cmp_eq_u32 s55, 0
    s_cbranch_scc0 Lo_44
    buffer_load_dwordx2 v[26:27], v28, s[16:19], 0 offen sc1
Lo_44:
    s_waitcnt vmcnt(17)
    s_barrier
    s_lshl_b32 s56, s55, 10
    s_add_u32 s56, s56, s78
    s_xor_b32 s57, s4, 229376
    s_add_u32 m0, s56, 101376
    s_nop 0
    buffer_load_dwordx4 v18, s[12:15], s57 offen lds
    s_add_u32 m0, s56, 105472
    s_add_u32 s57, s57, 524288
    buffer_load_dwordx4 v18, s[12:15], s57 offen lds
    s_add_u32 m0, s56, 109568
    s_add_u32 s57, s57, 524288
    buffer_load_dwordx4 v18, s[12:15], s57 offen lds
    s_add_u32 m0, s56, 113664
    s_add_u32 s57, s57, 524288
    buffer_load_dwordx4 v18, s[12:15], s57 offen lds
    s_add_u32 m0, s56, 117760
    s_add_u32 s57, s57, 524288
    buffer_load_dwordx4 v18, s[12:15], s57 offen lds
    s_add_u32 s78, s78, 20480
    s_cmp_ge_u32 s78, 61440
    s_cselect_b32 s78, 0, s78
    s_xor_b32 s82, s3, 512
    s_lshl_b32 s56, s55, 10
    s_add_u32 s56, s56, s77
    s_add_u32 m0, s56, 20480
    s_nop 0
    buffer_load_dwordx4 v13, s[8:11], s82 offen  lds
    s_add_u32 m0, s56, 24576
    s_nop 0
    buffer_load_dwordx4 v14, s[8:11], s82 offen  lds
    s_add_u32 m0, s56, 28672
    s_nop 0
    buffer_load_dwordx4 v15, s[8:11], s82 offen  lds
    s_cmp_lt_u32 s55, 1
    s_cbranch_scc0 Lx_45
    s_add_u32 m0, s56, 32768
    s_nop 0
    buffer_load_dwordx4 v16, s[8:11], s82 offen  lds
Lx_45:
    s_add_u32 s77, s77, 33792
    s_cmp_ge_u32 s77, 101376
    s_cselect_b32 s56, 101376, 0
    s_sub_u32 s77, s77, s56
    s_waitcnt vmcnt(13)
    s_barrier
    s_lshl_b32 s56, s55, 10
    s_add_u32 s56, s56, s78
    s_xor_b32 s57, s4, 262144
    s_add_u32 m0, s56, 101376
    s_nop 0
    buffer_load_dwordx4 v18, s[12:15], s57 offen lds
    s_add_u32 m0, s56, 105472
    s_add_u32 s57, s57, 524288
    buffer_load_dwordx4 v18, s[12:15], s57 offen lds
    s_add_u32 m0, s56, 109568
    s_add_u32 s57, s57, 524288
    buffer_load_dwordx4 v18, s[12:15], s57 offen lds
    s_add_u32 m0, s56, 113664
    s_add_u32 s57, s57, 524288
    buffer_load_dwordx4 v18, s[12:15], s57 offen lds
    s_add_u32 m0, s56, 117760
    s_add_u32 s57, s57, 524288
    buffer_load_dwordx4 v18, s[12:15], s57 offen lds
    s_add_u32 s78, s78, 20480
    s_cmp_ge_u32 s78, 61440
    s_cselect_b32 s78, 0, s78
    s_xor_b32 s82, s3, 640
    s_lshl_b32 s56, s55, 10
    s_add_u32 s56, s56, s77
    s_add_u32 m0, s56, 0
    s_nop 0
    buffer_load_dwordx4 v8, s[8:11], s82 offen  lds
    s_add_u32 m0, s56, 4096
    s_nop 0
    buffer_load_dwordx4 v9, s[8:11], s82 offen  lds
    s_add_u32 m0, s56, 8192
    s_nop 0
    buffer_load_dwordx4 v10, s[8:11], s82 offen  lds
    s_add_u32 m0, s56, 12288
    s_nop 0
    buffer_load_dwordx4 v11, s[8:11], s82 offen  lds
    s_add_u32 m0, s56, 16384
    s_nop 0
    buffer_load_dwordx4 v12, s[8:11], s82 offen  lds
    s_waitcnt vmcnt(13)
    s_barrier
    s_lshl_b32 s56, s55, 10
    s_add_u32 s56, s56, s78
    s_xor_b32 s57, s4, 294912
    s_add_u32 m0, s56, 101376
    s_nop 0
    buffer_load_dwordx4 v18, s[12:15], s57 offen lds
    s_add_u32 m0, s56, 105472
    s_add_u32 s57, s57, 524288
    buffer_load_dwordx4 v18, s[12:15], s57 offen lds
    s_add_u32 m0, s56, 109568
    s_add_u32 s57, s57, 524288
    buffer_load_dwordx4 v18, s[12:15], s57 offen lds
    s_add_u32 m0, s56, 113664
    s_add_u32 s57, s57, 524288
    buffer_load_dwordx4 v18, s[12:15], s57 offen lds
    s_add_u32 m0, s56, 117760
    s_add_u32 s57, s57, 524288
    buffer_load_dwordx4 v18, s[12:15], s57 offen lds
    s_add_u32 s78, s78, 20480
    s_cmp_ge_u32 s78, 61440
    s_cselect_b32 s78, 0, s78
    s_xor_b32 s82, s3, 640
    s_lshl_b32 s56, s55, 10
    s_add_u32 s56, s56, s77
    s_add_u32 m0, s56, 20480
    s_nop 0
    buffer_load_dwordx4 v13, s[8:11], s82 offen  lds
    s_add_u32 m0, s56, 24576
    s_nop 0
    buffer_load_dwordx4 v14, s[8:11], s82 offen  lds
    s_add_u32 m0, s56, 28672
    s_nop 0
    buffer_load_dwordx4 v15, s[8:11], s82 offen  lds
    s_cmp_lt_u32 s55, 1
    s_cbranch_scc0 Lx_46
    s_add_u32 m0, s56, 32768
    s_nop 0
    buffer_load_dwordx4 v16, s[8:11], s82 offen  lds
Lx_46:
    s_add_u32 s77, s77, 33792
    s_cmp_ge_u32 s77, 101376
    s_cselect_b32 s56, 101376, 0
    s_sub_u32 s77, s77, s56
    s_waitcnt vmcnt(13)
    s_barrier
    s_lshl_b32 s56, s55, 10
    s_add_u32 s56, s56, s78
    s_xor_b32 s57, s4, 327680
    s_add_u32 m0, s56, 101376
    s_nop 0
    buffer_load_dwordx4 v18, s[12:15], s57 offen lds
    s_add_u32 m0, s56, 105472
    s_add_u32 s57, s57, 524288
    buffer_load_dwordx4 v18, s[12:15], s57 offen lds
    s_add_u32 m0, s56, 109568
    s_add_u32 s57, s57, 524288
    buffer_load_dwordx4 v18, s[12:15], s57 offen lds
    s_add_u32 m0, s56, 113664
    s_add_u32 s57, s57, 524288
    buffer_load_dwordx4 v18, s[12:15], s57 offen lds
    s_add_u32 m0, s56, 117760
    s_add_u32 s57, s57, 524288
    buffer_load_dwordx4 v18, s[12:15], s57 offen lds
    s_add_u32 s78, s78, 20480
    s_cmp_ge_u32 s78, 61440
    s_cselect_b32 s78, 0, s78
    s_xor_b32 s82, s3, 768
    s_lshl_b32 s56, s55, 10
    s_add_u32 s56, s56, s77
    s_add_u32 m0, s56, 0
    s_nop 0
    buffer_load_dwordx4 v8, s[8:11], s82 offen  lds
    s_add_u32 m0, s56, 4096
    s_nop 0
    buffer_load_dwordx4 v9, s[8:11], s82 offen  lds
    s_add_u32 m0, s56, 8192
    s_nop 0
    buffer_load_dwordx4 v10, s[8:11], s82 offen  lds
    s_add_u32 m0, s56, 12288
    s_nop 0
    buffer_load_dwordx4 v11, s[8:11], s82 offen  lds
    s_add_u32 m0, s56, 16384
    s_nop 0
    buffer_load_dwordx4 v12, s[8:11], s82 offen  lds
    s_cmp_eq_u32 s55, 3
    s_cbranch_scc0 Lo_47
    s_mov_b32 s24, s32
    s_and_b32 s25, s33, 0xffff
    s_mov_b32 s26, 0x280000
    s_mov_b32 s27, 0x20000
    v_lshrrev_b32 v2, 3, v0
    v_lshlrev_b32 v2, 19, v2
    v_and_b32 v3, 7, v0
    v_lshl_add_u32 v2, v3, 15, v2
    s_lshl_b32 s56, s49, 10
    s_add_u32 s56, s56, 384
    v_add_u32 v2, s56, v2
    v_cmp_gt_u32 vcc, 40, v0
    v_mov_b32 v3, 0x80000000
    s_nop 0
    v_cndmask_b32 v2, v3, v2, vcc
    buffer_load_dword v208, v2, s[24:27], 0 offen
Lo_47:
    s_cmp_eq_u32 s55, 0
    s_cbranch_scc0 Lo_48
    s_waitcnt vmcnt(36)
    s_mov_b32 s72, 0
    v_cmp_ne_u32 vcc, s86, v26
    s_cbranch_vccz Lc_49
    s_mov_b32 s72, 0
Lp_50:
    buffer_load_dwordx2 v[26:27], v28, s[16:19], 0 offen sc1
    s_add_u32 s72, s72, 1
    s_cmp_ge_u32 s72, 40000
    s_cbranch_scc1 Lp_51
    s_waitcnt vmcnt(0)
    v_cmp_ne_u32 vcc, s86, v26
    s_cbranch_vccnz Lp_50
Lp_51:
    s_waitcnt vmcnt(0)
Lc_49:
    s_getreg_b32 s56, hwreg(HW_REG_XCC_ID, 0, 4)
    v_cmp_ne_u32 vcc, s56, v27
    s_nop 4
    s_cmp_eq_u64 vcc, 0
    s_cselect_b32 s87, 1, 0
    s_cmp_ge_u32 s72, 40000
    s_cselect_b32 s87, 0, s87
    v_mov_b32 v2, 163588
    v_mov_b32 v3, s87
    ds_write_b32 v2, v3
    s_waitcnt lgkmcnt(0)
Lo_48:
    s_waitcnt vmcnt(13)
    s_barrier
    s_lshl_b32 s56, s55, 10
    s_add_u32 s56, s56, s78
    s_xor_b32 s57, s4, 360448
    s_add_u32 m0, s56, 101376
    s_nop 0
    buffer_load_dwordx4 v18, s[12:15], s57 offen lds
    s_add_u32 m0, s56, 105472
    s_add_u32 s57, s57, 524288
    buffer_load_dwordx4 v18, s[12:15], s57 offen lds
    s_add_u32 m0, s56, 109568
    s_add_u32 s57, s57, 524288
    buffer_load_dwordx4 v18, s[12:15], s57 offen lds
    s_add_u32 m0, s56, 113664
    s_add_u32 s57, s57, 524288
    buffer_load_dwordx4 v18, s[12:15], s57 offen lds
    s_add_u32 m0, s56, 117760
    s_add_u32 s57, s57, 524288
    buffer_load_dwordx4 v18, s[12:15], s57 offen lds
    s_add_u32 s78, s78, 20480
    s_cmp_ge_u32 s78, 61440
    s_cselect_b32 s78, 0, s78
    s_xor_b32 s82, s3, 768
    s_lshl_b32 s56, s55, 10
    s_add_u32 s56, s56, s77
    s_add_u32 m0, s56, 20480
    s_nop 0
    buffer_load_dwordx4 v13, s[8:11], s82 offen  lds
    s_add_u32 m0, s56, 24576
    s_nop 0
    buffer_load_dwordx4 v14, s[8:11], s82 offen  lds
    s_add_u32 m0, s56, 28672
    s_nop 0
    buffer_load_dwordx4 v15, s[8:11], s82 offen  lds
    s_cmp_lt_u32 s55, 1
    s_cbranch_scc0 Lx_52
    s_add_u32 m0, s56, 32768
    s_nop 0
    buffer_load_dwordx4 v16, s[8:11], s82 offen  lds
Lx_52:
    s_add_u32 s77, s77, 33792
    s_cmp_ge_u32 s77, 101376
    s_cselect_b32 s56, 101376, 0
    s_sub_u32 s77, s77, s56
    s_waitcnt vmcnt(13)
    s_barrier
    s_lshl_b32 s56, s55, 10
    s_add_u32 s56, s56, s78
    s_xor_b32 s57, s4, 393216
    s_add_u32 m0, s56, 101376
    s_nop 0
    buffer_load_dwordx4 v18, s[12:15], s57 offen lds
    s_add_u32 m0, s56, 105472
    s_add_u32 s57, s57, 524288
    buffer_load_dwordx4 v18, s[12:15], s57 offen lds
    s_add_u32 m0, s56, 109568
    s_add_u32 s57, s57, 524288
    buffer_load_dwordx4 v18, s[12:15], s57 offen lds
    s_add_u32 m0, s56, 113664
    s_add_u32 s57, s57, 524288
    buffer_load_dwordx4 v18, s[12:15], s57 offen lds
    s_add_u32 m0, s56, 117760
    s_add_u32 s57, s57, 524288
    buffer_load_dwordx4 v18, s[12:15], s57 offen lds
    s_add_u32 s78, s78, 20480
    s_cmp_ge_u32 s78, 61440
    s_cselect_b32 s78, 0, s78
    s_xor_b32 s82, s3, 896
    s_lshl_b32 s56, s55, 10
    s_add_u32 s56, s56, s77
    s_add_u32 m0, s56, 0
    s_nop 0
    buffer_load_dwordx4 v8, s[8:11], s82 offen  lds
    s_add_u32 m0, s56, 4096
    s_nop 0
    buffer_load_dwordx4 v9, s[8:11], s82 offen  lds
    s_add_u32 m0, s56, 8192
    s_nop 0
    buffer_load_dwordx4 v10, s[8:11], s82 offen  lds
    s_add_u32 m0, s56, 12288
    s_nop 0
    buffer_load_dwordx4 v11, s[8:11], s82 offen  lds
    s_add_u32 m0, s56, 16384
    s_nop 0
    buffer_load_dwordx4 v12, s[8:11], s82 offen  lds
    s_cmp_eq_u32 s55, 3
    s_cbranch_scc0 Lo_53
    s_mov_b32 s24, s32
    s_and_b32 s25, s33, 0xffff
    s_mov_b32 s26, 0x280000
    s_mov_b32 s27, 0x20000
    v_lshrrev_b32 v2, 3, v0
    v_lshlrev_b32 v2, 19, v2
    v_and_b32 v3, 7, v0
    v_lshl_add_u32 v2, v3, 15, v2
    s_lshl_b32 s56, s49, 10
    s_add_u32 s56, s56, 262528
    v_add_u32 v2, s56, v2
    v_cmp_gt_u32 vcc, 40, v0
    v_mov_b32 v3, 0x80000000
    s_nop 0
    v_cndmask_b32 v2, v3, v2, vcc
    buffer_load_dword v208, v2, s[24:27], 0 offen
Lo_53:
    s_waitcnt vmcnt(13)
    s_barrier
    s_lshl_b32 s56, s55, 10
    s_add_u32 s56, s56, s78
    s_xor_b32 s57, s4, 425984
    s_add_u32 m0, s56, 101376
    s_nop 0
    buffer_load_dwordx4 v18, s[12:15], s57 offen lds
    s_add_u32 m0, s56, 105472
    s_add_u32 s57, s57, 524288
    buffer_load_dwordx4 v18, s[12:15], s57 offen lds
    s_add_u32 m0, s56, 109568
    s_add_u32 s57, s57, 524288
    buffer_load_dwordx4 v18, s[12:15], s57 offen lds
    s_add_u32 m0, s56, 113664
    s_add_u32 s57, s57, 524288
    buffer_load_dwordx4 v18, s[12:15], s57 offen lds
    s_add_u32 m0, s56, 117760
    s_add_u32 s57, s57, 524288
    buffer_load_dwordx4 v18, s[12:15], s57 offen lds
    s_add_u32 s78, s78, 20480
    s_cmp_ge_u32 s78, 61440
    s_cselect_b32 s78, 0, s78
    s_xor_b32 s82, s3, 896
    s_lshl_b32 s56, s55, 10
    s_add_u32 s56, s56, s77
    s_add_u32 m0, s56, 20480
    s_nop 0
    buffer_load_dwordx4 v13, s[8:11], s82 offen  lds
    s_add_u32 m0, s56, 24576
    s_nop 0
    buffer_load_dwordx4 v14, s[8:11], s82 offen  lds
    s_add_u32 m0, s56, 28672
    s_nop 0
    buffer_load_dwordx4 v15, s[8:11], s82 offen  lds
    s_cmp_lt_u32 s55, 1
    s_cbranch_scc0 Lx_54
    s_add_u32 m0, s56, 32768
    s_nop 0
    buffer_load_dwordx4 v16, s[8:11], s82 offen  lds
Lx_54:
    s_add_u32 s77, s77, 33792
    s_cmp_ge_u32 s77, 101376
    s_cselect_b32 s56, 101376, 0
    s_sub_u32 s77, s77, s56
    s_waitcnt vmcnt(13)
    s_barrier
    s_lshl_b32 s56, s55, 10
    s_add_u32 s56, s56, s78
    s_xor_b32 s57, s4, 458752
    s_add_u32 m0, s56, 101376
    s_nop 0
    buffer_load_dwordx4 v18, s[12:15], s57 offen lds
    s_add_u32 m0, s56, 105472
    s_add_u32 s57, s57, 524288
    buffer_load_dwordx4 v18, s[12:15], s57 offen lds
    s_add_u32 m0, s56, 109568
    s_add_u32 s57, s57, 524288
    buffer_load_dwordx4 v18, s[12:15], s57 offen lds
    s_add_u32 m0, s56, 113664
    s_add_u32 s57, s57, 524288
    buffer_load_dwordx4 v18, s[12:15], s57 offen lds
    s_add_u32 m0, s56, 117760
    s_add_u32 s57, s57, 524288
    buffer_load_dwordx4 v18, s[12:15], s57 offen lds
    s_add_u32 s78, s78, 20480
    s_cmp_ge_u32 s78, 61440
    s_cselect_b32 s78, 0, s78
    s_waitcnt vmcnt(8)
    s_barrier
    s_lshl_b32 s56, s55, 10
    s_add_u32 s56, s56, s78
    s_xor_b32 s57, s4, 491520
    s_add_u32 m0, s56, 101376
    s_nop 0
    buffer_load_dwordx4 v18, s[12:15], s57 offen lds
    s_add_u32 m0, s56, 105472
    s_add_u32 s57, s57, 524288
    buffer_load_dwordx4 v18, s[12:15], s57 offen lds
    s_add_u32 m0, s56, 109568
    s_add_u32 s57, s57, 524288
    buffer_load_dwordx4 v18, s[12:15], s57 offen lds
    s_add_u32 m0, s56, 113664
    s_add_u32 s57, s57, 524288
    buffer_load_dwordx4 v18, s[12:15], s57 offen lds
    s_add_u32 m0, s56, 117760
    s_add_u32 s57, s57, 524288
    buffer_load_dwordx4 v18, s[12:15], s57 offen lds
    s_add_u32 s78, s78, 20480
    s_cmp_ge_u32 s78, 61440
    s_cselect_b32 s78, 0, s78
    s_waitcnt vmcnt(5)
    s_barrier
    s_cmp_ge_u32 s2, 224
    s_cselect_b32 s56, s55, 0
    s_cmp_eq_u32 s56, 2
    s_cbranch_scc0 Lo_55
    s_sub_u32 s64, s2, 224
    s_mov_b32 s24, s38
    s_and_b32 s25, s39, 0xffff
    s_mov_b32 s26, 0x80000
    s_mov_b32 s27, 0x20000
    v_lshrrev_b32 v2, 1, v0
    v_and_b32 v3, 1, v0
    v_lshlrev_b32 v3, 4, v3
    v_lshl_add_u32 v2, v2, 10, v3
    s_lshl_b32 s65, s64, 5
    v_add_u32 v2, s65, v2
    s_mov_b32 s66, 0
    buffer_load_dwordx4 v[100:103], v2, s[24:27], s66 offen
    s_add_u32 s66, s66, 32768
    buffer_load_dwordx4 v[104:107], v2, s[24:27], s66 offen
    s_add_u32 s66, s66, 32768
    buffer_load_dwordx4 v[108:111], v2, s[24:27], s66 offen
    s_add_u32 s66, s66, 32768
    buffer_load_dwordx4 v[112:115], v2, s[24:27], s66 offen
    s_add_u32 s66, s66, 32768
    buffer_load_dwordx4 v[116:119], v2, s[24:27], s66 offen
    s_add_u32 s66, s66, 32768
    buffer_load_dwordx4 v[120:123], v2, s[24:27], s66 offen
    s_add_u32 s66, s66, 32768
    buffer_load_dwordx4 v[124:127], v2, s[24:27], s66 offen
    s_add_u32 s66, s66, 32768
    buffer_load_dwordx4 v[128:131], v2, s[24:27], s66 offen
    s_add_u32 s66, s66, 32768
    buffer_load_dwordx4 v[132:135], v2, s[24:27], s66 offen
    s_add_u32 s66, s66, 32768
    buffer_load_dwordx4 v[136:139], v2, s[24:27], s66 offen
    s_add_u32 s66, s66, 32768
    buffer_load_dwordx4 v[140:143], v2, s[24:27], s66 offen
    s_add_u32 s66, s66, 32768
    buffer_load_dwordx4 v[144:147], v2, s[24:27], s66 offen
    s_add_u32 s66, s66, 32768
    buffer_load_dwordx4 v[148:151], v2, s[24:27], s66 offen
    s_add_u32 s66, s66, 32768
    buffer_load_dwordx4 v[152:155], v2, s[24:27], s66 offen
    s_add_u32 s66, s66, 32768
    buffer_load_dwordx4 v[156:159], v2, s[24:27], s66 offen
    s_add_u32 s66, s66, 32768
    buffer_load_dwordx4 v[160:163], v2, s[24:27], s66 offen
    s_add_u32 s66, s66, 32768
Lo_55:
    s_cmp_ge_u32 s2, 224
    s_cselect_b32 s56, s55, 0
    s_cmp_eq_u32 s56, 2
    s_cbranch_scc1 Lv_56
    s_waitcnt vmcnt(0)
    s_branch Lv_57
Lv_56:
    s_waitcnt vmcnt(16)
Lv_57:
    s_barrier
    s_barrier
    s_mov_b32 s12, s32
    s_and_b32 s13, s33, 0xffff
    s_mov_b32 s14, 0x280000
    s_mov_b32 s15, 0x20000
    s_lshl_b32 s56, s48, 19
    s_add_u32 s56, s56, 0
    s_add_u32 s8, s46, s56
    s_addc_u32 s9, s47, 0
    s_and_b32 s9, s9, 0xffff
    s_mov_b32 s10, 0x100000
    s_mov_b32 s11, 0x20000
    s_mov_b32 s77, 0
    s_mov_b32 s78, 0
    s_lshl_b32 s56, s55, 10
    s_add_u32 s56, s56, s78
    s_xor_b32 s57, s4, 0
    s_add_u32 m0, s56, 52224
    s_nop 0
    buffer_load_dwordx4 v18, s[12:15], s57 offen lds
    s_add_u32 m0, s56, 56320
    s_add_u32 s57, s57, 524288
    buffer_load_dwordx4 v18, s[12:15], s57 offen lds
    s_add_u32 m0, s56, 60416
    s_add_u32 s57, s57, 524288
    buffer_load_dwordx4 v18, s[12:15], s57 offen lds
    s_add_u32 m0, s56, 64512
    s_add_u32 s57, s57, 524288
    buffer_load_dwordx4 v18, s[12:15], s57 offen lds
    s_add_u32 m0, s56, 68608
    s_add_u32 s57, s57, 524288
    buffer_load_dwordx4 v18, s[12:15], s57 offen lds
    s_add_u32 s78, s78, 20480
    s_cmp_ge_u32 s78, 102400
    s_cselect_b32 s78, 0, s78
    s_lshl_b32 s56, s55, 10
    s_add_u32 s56, s56, s78
    s_xor_b32 s57, s4, 32768
    s_add_u32 m0, s56, 52224
    s_nop 0
    buffer_load_dwordx4 v18, s[12:15], s57 offen lds
    s_add_u32 m0, s56, 56320
    s_add_u32 s57, s57, 524288
    buffer_load_dwordx4 v18, s[12:15], s57 offen lds
    s_add_u32 m0, s56, 60416
    s_add_u32 s57, s57, 524288
    buffer_load_dwordx4 v18, s[12:15], s57 offen lds
    s_add_u32 m0, s56, 64512
    s_add_u32 s57, s57, 524288
    buffer_load_dwordx4 v18, s[12:15], s57 offen lds
    s_add_u32 m0, s56, 68608
    s_add_u32 s57, s57, 524288
    buffer_load_dwordx4 v18, s[12:15], s57 offen lds
    s_add_u32 s78, s78, 20480
    s_cmp_ge_u32 s78, 102400
    s_cselect_b32 s78, 0, s78
    s_cmp_ge_u32 s2, 224
    s_cselect_b32 s56, s55, 0
    s_cmp_eq_u32 s56, 2
    s_cbranch_scc0 Lo_58
    v_lshlrev_b32 v2, 4, v0
    v_add_u32 v2, 17408, v2
    s_waitcnt vmcnt(10)
    ds_write_b128 v2, v[100:103] offset:0
    ds_write_b128 v2, v[104:107] offset:1024
    ds_write_b128 v2, v[108:111] offset:2048
    ds_write_b128 v2, v[112:115] offset:3072
    ds_write_b128 v2, v[116:119] offset:4096
    ds_write_b128 v2, v[120:123] offset:5120
    ds_write_b128 v2, v[124:127] offset:6144
    ds_write_b128 v2, v[128:131] offset:7168
    ds_write_b128 v2, v[132:135] offset:8192
    ds_write_b128 v2, v[136:139] offset:9216
    ds_write_b128 v2, v[140:143] offset:10240
    ds_write_b128 v2, v[144:147] offset:11264
    ds_write_b128 v2, v[148:151] offset:12288
    ds_write_b128 v2, v[152:155] offset:13312
    ds_write_b128 v2, v[156:159] offset:14336
    ds_write_b128 v2, v[160:163] offset:15360
    s_waitcnt lgkmcnt(0)
    v_mov_b32 v2, 163696
    v_mov_b32 v3, 1
    ds_write_b32 v2, v3
    s_waitcnt lgkmcnt(0)
Lo_58:
    s_lshl_b32 s64, s52, 7
    s_cmp_eq_u32 s51, 0
    s_cselect_b32 s66, 2, 0
    s_cmp_eq_u32 s51, 3
    s_cselect_b32 s67, 0, 522
    s_add_u32 s67, s67, 502
    s_sub_u32 s67, s67, s66
    v_lshrrev_b32 v2, 3, v0
    v_and_b32 v3, 7, v0
    s_lshl_b32 s56, s55, 3
    s_mov_b32 s57, 3856
    s_mov_b32 s58, 0x42764210
    v_mov_b32 v7, 0x80000000
    v_add_u32 v4, s56, v2
    v_mul_u32_u24 v5, s57, v4
    v_lshrrev_b32 v5, 16, v5
    v_mul_u32_u24 v6, 17, v5
    v_sub_u32 v6, v4, v6
    v_and_b32 v20, 3, v5
    v_lshl_add_u32 v20, v6, 2, v20
    v_lshrrev_b32 v21, 2, v5
    v_lshl_add_u32 v20, v20, 1, v21
    v_add_u32 v20, s64, v20
    v_subrev_u32 v22, s66, v20
    v_cmp_gt_u32 vcc, s67, v22
    v_lshlrev_b32 v21, 1, v6
    v_and_b32 v21, 28, v21
    v_lshrrev_b32 v21, v21, s58
    v_and_b32 v21, 7, v21
    v_xor_b32 v21, v21, v3
    v_lshlrev_b32 v21, 4, v21
    v_lshl_add_u32 v21, v20, 10, v21
    v_cndmask_b32 v8, v7, v21, vcc
    v_add_u32 v4, 32, v4
    v_mul_u32_u24 v5, s57, v4
    v_lshrrev_b32 v5, 16, v5
    v_mul_u32_u24 v6, 17, v5
    v_sub_u32 v6, v4, v6
    v_and_b32 v20, 3, v5
    v_lshl_add_u32 v20, v6, 2, v20
    v_lshrrev_b32 v21, 2, v5
    v_lshl_add_u32 v20, v20, 1, v21
    v_add_u32 v20, s64, v20
    v_subrev_u32 v22, s66, v20
    v_cmp_gt_u32 vcc, s67, v22
    v_lshlrev_b32 v21, 1, v6
    v_and_b32 v21, 28, v21
    v_lshrrev_b32 v21, v21, s58
    v_and_b32 v21, 7, v21
    v_xor_b32 v21, v21, v3
    v_lshlrev_b32 v21, 4, v21
    v_lshl_add_u32 v21, v20, 10, v21
    v_cndmask_b32 v9, v7, v21, vcc
    v_add_u32 v4, 32, v4
    v_mul_u32_u24 v5, s57, v4
    v_lshrrev_b32 v5, 16, v5
    v_mul_u32_u24 v6, 17, v5
    v_sub_u32 v6, v4, v6
    v_and_b32 v20, 3, v5
    v_lshl_add_u32 v20, v6, 2, v20
    v_lshrrev_b32 v21, 2, v5
    v_lshl_add_u32 v20, v20, 1, v21
    v_add_u32 v20, s64, v20
    v_subrev_u32 v22, s66, v20
    v_cmp_gt_u32 vcc, s67, v22
    v_lshlrev_b32 v21, 1, v6
    v_and_b32 v21, 28, v21
    v_lshrrev_b32 v21, v21, s58
    v_and_b32 v21, 7, v21
    v_xor_b32 v21, v21, v3
    v_lshlrev_b32 v21, 4, v21
    v_lshl_add_u32 v21, v20, 10, v21
    v_cndmask_b32 v10, v7, v21, vcc
    v_add_u32 v4, 32, v4
    v_mul_u32_u24 v5, s57, v4
    v_lshrrev_b32 v5, 16, v5
    v_mul_u32_u24 v6, 17, v5
    v_sub_u32 v6, v4, v6
    v_and_b32 v20, 3, v5
    v_lshl_add_u32 v20, v6, 2, v20
    v_lshrrev_b32 v21, 2, v5
    v_lshl_add_u32 v20, v20, 1, v21
    v_add_u32 v20, s64, v20
    v_subrev_u32 v22, s66, v20
    v_cmp_gt_u32 vcc, s67, v22
    v_lshlrev_b32 v21, 1, v6
    v_and_b32 v21, 28, v21
    v_lshrrev_b32 v21, v21, s58
    v_and_b32 v21, 7, v21
    v_xor_b32 v21, v21, v3
    v_lshlrev_b32 v21, 4, v21
    v_lshl_add_u32 v21, v20, 10, v21
    v_cndmask_b32 v11, v7, v21, vcc
    v_add_u32 v4, 32, v4
    v_mul_u32_u24 v5, s57, v4
    v_lshrrev_b32 v5, 16, v5
    v_mul_u32_u24 v6, 17, v5
    v_sub_u32 v6, v4, v6
    v_and_b32 v20, 3, v5
    v_lshl_add_u32 v20, v6, 2, v20
    v_lshrrev_b32 v21, 2, v5
    v_lshl_add_u32 v20, v20, 1, v21
    v_add_u32 v20, s64, v20
    v_subrev_u32 v22, s66, v20
    v_cmp_gt_u32 vcc, s67, v22
    v_lshlrev_b32 v21, 1, v6
    v_and_b32 v21, 28, v21
    v_lshrrev_b32 v21, v21, s58
    v_and_b32 v21, 7, v21
    v_xor_b32 v21, v21, v3
    v_lshlrev_b32 v21, 4, v21
    v_lshl_add_u32 v21, v20, 10, v21
    v_cndmask_b32 v12, v7, v21, vcc
    v_cmp_gt_u32 vcc, 136, v4
    s_nop 1
    v_cndmask_b32 v12, v7, v12, vcc
    s_lshl_b32 s56, s52, 3
    v_lshrrev_b32 v6, 2, v0
    v_add_u32 v6, s56, v6
    v_min_u32 v6, 31, v6
    v_lshlrev_b32 v6, 4, v6
    v_and_b32 v7, 3, v0
    v_lshl_add_u32 v6, v7, 2, v6
    s_lshl_b32 s56, s48, 9
    s_add_u32 s56, s56, 15933440
    v_add_u32 v6, s56, v6
    s_mov_b32 s72, 0
Lp_59:
    buffer_load_dword v7, v6, s[16:19], 0 offen sc1
    s_add_u32 s72, s72, 1
    s_cmp_ge_u32 s72, 40000
    s_cbranch_scc1 Lp_60
    s_waitcnt vmcnt(0)
    v_cmp_ne_u32 vcc, s86, v7
    s_cbranch_vccnz Lp_59
Lp_60:
    s_waitcnt vmcnt(0)
    s_xor_b32 s82, s3, 0
    s_lshl_b32 s56, s55, 10
    s_add_u32 s56, s56, s77
    s_add_u32 m0, s56, 0
    s_nop 0
    buffer_load_dwordx4 v8, s[8:11], s82 offen sc1 lds
    s_add_u32 m0, s56, 4096
    s_nop 0
    buffer_load_dwordx4 v9, s[8:11], s82 offen sc1 lds
    s_add_u32 m0, s56, 8192
    s_nop 0
    buffer_load_dwordx4 v10, s[8:11], s82 offen sc1 lds
    s_add_u32 m0, s56, 12288
    s_nop 0
    buffer_load_dwordx4 v11, s[8:11], s82 offen sc1 lds
    s_cmp_lt_u32 s55, 1
    s_cbranch_scc0 Lx_61
    s_add_u32 m0, s56, 16384
    s_nop 0
    buffer_load_dwordx4 v12, s[8:11], s82 offen sc1 lds
Lx_61:
    s_add_u32 s77, s77, 34816
    s_cmp_ge_u32 s77, 52224
    s_cselect_b32 s56, 52224, 0
    s_sub_u32 s77, s77, s56
    s_lshl_b32 s56, s55, 10
    s_add_u32 s56, s56, s78
    s_xor_b32 s57, s4, 65536
    s_add_u32 m0, s56, 52224
    s_nop 0
    buffer_load_dwordx4 v18, s[12:15], s57 offen lds
    s_add_u32 m0, s56, 56320
    s_add_u32 s57, s57, 524288
    buffer_load_dwordx4 v18, s[12:15], s57 offen lds
    s_add_u32 m0, s56, 60416
    s_add_u32 s57, s57, 524288
    buffer_load_dwordx4 v18, s[12:15], s57 offen lds
    s_add_u32 m0, s56, 64512
    s_add_u32 s57, s57, 524288
    buffer_load_dwordx4 v18, s[12:15], s57 offen lds
    s_add_u32 m0, s56, 68608
    s_add_u32 s57, s57, 524288
    buffer_load_dwordx4 v18, s[12:15], s57 offen lds
    s_add_u32 s78, s78, 20480
    s_cmp_ge_u32 s78, 102400
    s_cselect_b32 s78, 0, s78
    s_xor_b32 s82, s3, 128
    s_lshl_b32 s56, s55, 10
    s_add_u32 s56, s56, s77
    s_add_u32 m0, s56, 0
    s_nop 0
    buffer_load_dwordx4 v8, s[8:11], s82 offen sc1 lds
    s_add_u32 m0, s56, 4096
    s_nop 0
    buffer_load_dwordx4 v9, s[8:11], s82 offen sc1 lds
    s_add_u32 m0, s56, 8192
    s_nop 0
    buffer_load_dwordx4 v10, s[8:11], s82 offen sc1 lds
    s_add_u32 m0, s56, 12288
    s_nop 0
    buffer_load_dwordx4 v11, s[8:11], s82 offen sc1 lds
    s_cmp_lt_u32 s55, 1
    s_cbranch_scc0 Lx_62
    s_add_u32 m0, s56, 16384
    s_nop 0
    buffer_load_dwordx4 v12, s[8:11], s82 offen sc1 lds
Lx_62:
    s_add_u32 s77, s77, 34816
    s_cmp_ge_u32 s77, 52224
    s_cselect_b32 s56, 52224, 0
    s_sub_u32 s77, s77, s56
    s_lshl_b32 s56, s55, 10
    s_add_u32 s56, s56, s78
    s_xor_b32 s57, s4, 98304
    s_add_u32 m0, s56, 52224
    s_nop 0
    buffer_load_dwordx4 v18, s[12:15], s57 offen lds
    s_add_u32 m0, s56, 56320
    s_add_u32 s57, s57, 524288
    buffer_load_dwordx4 v18, s[12:15], s57 offen lds
    s_add_u32 m0, s56, 60416
    s_add_u32 s57, s57, 524288
    buffer_load_dwordx4 v18, s[12:15], s57 offen lds
    s_add_u32 m0, s56, 64512
    s_add_u32 s57, s57, 524288
    buffer_load_dwordx4 v18, s[12:15], s57 offen lds
    s_add_u32 m0, s56, 68608
    s_add_u32 s57, s57, 524288
    buffer_load_dwordx4 v18, s[12:15], s57 offen lds
    s_add_u32 s78, s78, 20480
    s_cmp_ge_u32 s78, 102400
    s_cselect_b32 s78, 0, s78
    s_waitcnt vmcnt(14) lgkmcnt(0)
    s_barrier
    s_lshl_b32 s56, s55, 10
    s_add_u32 s56, s56, s78
    s_xor_b32 s57, s4, 131072
    s_add_u32 m0, s56, 52224
    s_nop 0
    buffer_load_dwordx4 v18, s[12:15], s57 offen lds
    s_add_u32 m0, s56, 56320
    s_add_u32 s57, s57, 524288
    buffer_load_dwordx4 v18, s[12:15], s57 offen lds
    s_add_u32 m0, s56, 60416
    s_add_u32 s57, s57, 524288
    buffer_load_dwordx4 v18, s[12:15], s57 offen lds
    s_add_u32 m0, s56, 64512
    s_add_u32 s57, s57, 524288
    buffer_load_dwordx4 v18, s[12:15], s57 offen lds
    s_add_u32 m0, s56, 68608
    s_add_u32 s57, s57, 524288
    buffer_load_dwordx4 v18, s[12:15], s57 offen lds
    s_add_u32 s78, s78, 20480
    s_cmp_ge_u32 s78, 102400
    s_cselect_b32 s78, 0, s78
    s_xor_b32 s82, s3, 256
    s_lshl_b32 s56, s55, 10
    s_add_u32 s56, s56, s77
    s_add_u32 m0, s56, 0
    s_nop 0
    buffer_load_dwordx4 v8, s[8:11], s82 offen sc1 lds
    s_add_u32 m0, s56, 4096
    s_nop 0
    buffer_load_dwordx4 v9, s[8:11], s82 offen sc1 lds
    s_add_u32 m0, s56, 8192
    s_nop 0
    buffer_load_dwordx4 v10, s[8:11], s82 offen sc1 lds
    s_add_u32 m0, s56, 12288
    s_nop 0
    buffer_load_dwordx4 v11, s[8:11], s82 offen sc1 lds
    s_cmp_lt_u32 s55, 1
    s_cbranch_scc0 Lx_63
    s_add_u32 m0, s56, 16384
    s_nop 0
    buffer_load_dwordx4 v12, s[8:11], s82 offen sc1 lds
Lx_63:
    s_add_u32 s77, s77, 34816
    s_cmp_ge_u32 s77, 52224
    s_cselect_b32 s56, 52224, 0
    s_sub_u32 s77, s77, s56
    s_waitcnt vmcnt(9)
    s_barrier
    s_lshl_b32 s56, s55, 10
    s_add_u32 s56, s56, s78
    s_xor_b32 s57, s4, 163840
    s_add_u32 m0, s56, 52224
    s_nop 0
    buffer_load_dwordx4 v18, s[12:15], s57 offen lds
    s_add_u32 m0, s56, 56320
    s_add_u32 s57, s57, 524288
    buffer_load_dwordx4 v18, s[12:15], s57 offen lds
    s_add_u32 m0, s56, 60416
    s_add_u32 s57, s57, 524288
    buffer_load_dwordx4 v18, s[12:15], s57 offen lds
    s_add_u32 m0, s56, 64512
    s_add_u32 s57, s57, 524288
    buffer_load_dwordx4 v18, s[12:15], s57 offen lds
    s_add_u32 m0, s56, 68608
    s_add_u32 s57, s57, 524288
    buffer_load_dwordx4 v18, s[12:15], s57 offen lds
    s_add_u32 s78, s78, 20480
    s_cmp_ge_u32 s78, 102400
    s_cselect_b32 s78, 0, s78
    s_xor_b32 s82, s3, 384
    s_lshl_b32 s56, s55, 10
    s_add_u32 s56, s56, s77
    s_add_u32 m0, s56, 0
    s_nop 0
    buffer_load_dwordx4 v8, s[8:11], s82 offen sc1 lds
    s_add_u32 m0, s56, 4096
    s_nop 0
    buffer_load_dwordx4 v9, s[8:11], s82 offen sc1 lds
    s_add_u32 m0, s56, 8192
    s_nop 0
    buffer_load_dwordx4 v10, s[8:11], s82 offen sc1 lds
    s_add_u32 m0, s56, 12288
    s_nop 0
    buffer_load_dwordx4 v11, s[8:11], s82 offen sc1 lds
    s_cmp_lt_u32 s55, 1
    s_cbranch_scc0 Lx_64
    s_add_u32 m0, s56, 16384
    s_nop 0
    buffer_load_dwordx4 v12, s[8:11], s82 offen sc1 lds
Lx_64:
    s_add_u32 s77, s77, 34816
    s_cmp_ge_u32 s77, 52224
    s_cselect_b32 s56, 52224, 0
    s_sub_u32 s77, s77, s56
    s_lshl_b32 s56, s55, 10
    s_add_u32 s56, s56, s78
    s_xor_b32 s57, s4, 196608
    s_add_u32 m0, s56, 52224
    s_nop 0
    buffer_load_dwordx4 v18, s[12:15], s57 offen lds
    s_add_u32 m0, s56, 56320
    s_add_u32 s57, s57, 524288
    buffer_load_dwordx4 v18, s[12:15], s57 offen lds
    s_add_u32 m0, s56, 60416
    s_add_u32 s57, s57, 524288
    buffer_load_dwordx4 v18, s[12:15], s57 offen lds
    s_add_u32 m0, s56, 64512
    s_add_u32 s57, s57, 524288
    buffer_load_dwordx4 v18, s[12:15], s57 offen lds
    s_add_u32 m0, s56, 68608
    s_add_u32 s57, s57, 524288
    buffer_load_dwordx4 v18, s[12:15], s57 offen lds
    s_add_u32 s78, s78, 20480
    s_cmp_ge_u32 s78, 102400
    s_cselect_b32 s78, 0, s78
    s_waitcnt vmcnt(9)
    s_barrier
    s_lshl_b32 s56, s55, 10
    s_add_u32 s56, s56, s78
    s_xor_b32 s57, s4, 229376
    s_add_u32 m0, s56, 52224
    s_nop 0
    buffer_load_dwordx4 v18, s[12:15], s57 offen lds
    s_add_u32 m0, s56, 56320
    s_add_u32 s57, s57, 524288
    buffer_load_dwordx4 v18, s[12:15], s57 offen lds
    s_add_u32 m0, s56, 60416
    s_add_u32 s57, s57, 524288
    buffer_load_dwordx4 v18, s[12:15], s57 offen lds
    s_add_u32 m0, s56, 64512
    s_add_u32 s57, s57, 524288
    buffer_load_dwordx4 v18, s[12:15], s57 offen lds
    s_add_u32 m0, s56, 68608
    s_add_u32 s57, s57, 524288
    buffer_load_dwordx4 v18, s[12:15], s57 offen lds
    s_add_u32 s78, s78, 20480
    s_cmp_ge_u32 s78, 102400
    s_cselect_b32 s78, 0, s78
    s_xor_b32 s82, s3, 512
    s_lshl_b32 s56, s55, 10
    s_add_u32 s56, s56, s77
    s_add_u32 m0, s56, 0
    s_nop 0
    buffer_load_dwordx4 v8, s[8:11], s82 offen sc1 lds
    s_add_u32 m0, s56, 4096
    s_nop 0
    buffer_load_dwordx4 v9, s[8:11], s82 offen sc1 lds
    s_add_u32 m0, s56, 8192
    s_nop 0
    buffer_load_dwordx4 v10, s[8:11], s82 offen sc1 lds
    s_add_u32 m0, s56, 12288
    s_nop 0
    buffer_load_dwordx4 v11, s[8:11], s82 offen sc1 lds
    s_cmp_lt_u32 s55, 1
    s_cbranch_scc0 Lx_65
    s_add_u32 m0, s56, 16384
    s_nop 0
    buffer_load_dwordx4 v12, s[8:11], s82 offen sc1 lds
Lx_65:
    s_add_u32 s77, s77, 34816
    s_cmp_ge_u32 s77, 52224
    s_cselect_b32 s56, 52224, 0
    s_sub_u32 s77, s77, s56
    s_lshl_b32 s56, s55, 10
    s_add_u32 s56, s56, s78
    s_xor_b32 s57, s4, 262144
    s_add_u32 m0, s56, 52224
    s_nop 0
    buffer_load_dwordx4 v18, s[12:15], s57 offen lds
    s_add_u32 m0, s56, 56320
    s_add_u32 s57, s57, 524288
    buffer_load_dwordx4 v18, s[12:15], s57 offen lds
    s_add_u32 m0, s56, 60416
    s_add_u32 s57, s57, 524288
    buffer_load_dwordx4 v18, s[12:15], s57 offen lds
    s_add_u32 m0, s56, 64512
    s_add_u32 s57, s57, 524288
    buffer_load_dwordx4 v18, s[12:15], s57 offen lds
    s_add_u32 m0, s56, 68608
    s_add_u32 s57, s57, 524288
    buffer_load_dwordx4 v18, s[12:15], s57 offen lds
    s_add_u32 s78, s78, 20480
    s_cmp_ge_u32 s78, 102400
    s_cselect_b32 s78, 0, s78
    s_waitcnt vmcnt(9)
    s_barrier
    s_lshl_b32 s56, s55, 10
    s_add_u32 s56, s56, s78
    s_xor_b32 s57, s4, 294912
    s_add_u32 m0, s56, 52224
    s_nop 0
    buffer_load_dwordx4 v18, s[12:15], s57 offen lds
    s_add_u32 m0, s56, 56320
    s_add_u32 s57, s57, 524288
    buffer_load_dwordx4 v18, s[12:15], s57 offen lds
    s_add_u32 m0, s56, 60416
    s_add_u32 s57, s57, 524288
    buffer_load_dwordx4 v18, s[12:15], s57 offen lds
    s_add_u32 m0, s56, 64512
    s_add_u32 s57, s57, 524288
    buffer_load_dwordx4 v18, s[12:15], s57 offen lds
    s_add_u32 m0, s56, 68608
    s_add_u32 s57, s57, 524288
    buffer_load_dwordx4 v18, s[12:15], s57 offen lds
    s_add_u32 s78, s78, 20480
    s_cmp_ge_u32 s78, 102400
    s_cselect_b32 s78, 0, s78
    s_xor_b32 s82, s3, 640
    s_lshl_b32 s56, s55, 10
    s_add_u32 s56, s56, s77
    s_add_u32 m0, s56, 0
    s_nop 0
    buffer_load_dwordx4 v8, s[8:11], s82 offen sc1 lds
    s_add_u32 m0, s56, 4096
    s_nop 0
    buffer_load_dwordx4 v9, s[8:11], s82 offen sc1 lds
    s_add_u32 m0, s56, 8192
    s_nop 0
    buffer_load_dwordx4 v10, s[8:11], s82 offen sc1 lds
    s_add_u32 m0, s56, 12288
    s_nop 0
    buffer_load_dwordx4 v11, s[8:11], s82 offen sc1 lds
    s_cmp_lt_u32 s55, 1
    s_cbranch_scc0 Lx_66
    s_add_u32 m0, s56, 16384
    s_nop 0
    buffer_load_dwordx4 v12, s[8:11], s82 offen sc1 lds
Lx_66:
    s_add_u32 s77, s77, 34816
    s_cmp_ge_u32 s77, 52224
    s_cselect_b32 s56, 52224, 0
    s_sub_u32 s77, s77, s56
    s_lshl_b32 s56, s55, 10
    s_add_u32 s56, s56, s78
    s_xor_b32 s57, s4, 327680
    s_add_u32 m0, s56, 52224
    s_nop 0
    buffer_load_dwordx4 v18, s[12:15], s57 offen lds
    s_add_u32 m0, s56, 56320
    s_add_u32 s57, s57, 524288
    buffer_load_dwordx4 v18, s[12:15], s57 offen lds
    s_add_u32 m0, s56, 60416
    s_add_u32 s57, s57, 524288
    buffer_load_dwordx4 v18, s[12:15], s57 offen lds
    s_add_u32 m0, s56, 64512
    s_add_u32 s57, s57, 524288
    buffer_load_dwordx4 v18, s[12:15], s57 offen lds
    s_add_u32 m0, s56, 68608
    s_add_u32 s57, s57, 524288
    buffer_load_dwordx4 v18, s[12:15], s57 offen lds
    s_add_u32 s78, s78, 20480
    s_cmp_ge_u32 s78, 102400
    s_cselect_b32 s78, 0, s78
    s_waitcnt vmcnt(9)
    s_barrier
    s_lshl_b32 s56, s55, 10
    s_add_u32 s56, s56, s78
    s_xor_b32 s57, s4, 360448
    s_add_u32 m0, s56, 52224
    s_nop 0
    buffer_load_dwordx4 v18, s[12:15], s57 offen lds
    s_add_u32 m0, s56, 56320
    s_add_u32 s57, s57, 524288
    buffer_load_dwordx4 v18, s[12:15], s57 offen lds
    s_add_u32 m0, s56, 60416
    s_add_u32 s57, s57, 524288
    buffer_load_dwordx4 v18, s[12:15], s57 offen lds
    s_add_u32 m0, s56, 64512
    s_add_u32 s57, s57, 524288
    buffer_load_dwordx4 v18, s[12:15], s57 offen lds
    s_add_u32 m0, s56, 68608
    s_add_u32 s57, s57, 524288
    buffer_load_dwordx4 v18, s[12:15], s57 offen lds
    s_add_u32 s78, s78, 20480
    s_cmp_ge_u32 s78, 102400
    s_cselect_b32 s78, 0, s78
    s_xor_b32 s82, s3, 768
    s_lshl_b32 s56, s55, 10
    s_add_u32 s56, s56, s77
    s_add_u32 m0, s56, 0
    s_nop 0
    buffer_load_dwordx4 v8, s[8:11], s82 offen sc1 lds
    s_add_u32 m0, s56, 4096
    s_nop 0
    buffer_load_dwordx4 v9, s[8:11], s82 offen sc1 lds
    s_add_u32 m0, s56, 8192
    s_nop 0
    buffer_load_dwordx4 v10, s[8:11], s82 offen sc1 lds
    s_add_u32 m0, s56, 12288
    s_nop 0
    buffer_load_dwordx4 v11, s[8:11], s82 offen sc1 lds
    s_cmp_lt_u32 s55, 1
    s_cbranch_scc0 Lx_67
    s_add_u32 m0, s56, 16384
    s_nop 0
    buffer_load_dwordx4 v12, s[8:11], s82 offen sc1 lds
Lx_67:
    s_add_u32 s77, s77, 34816
    s_cmp_ge_u32 s77, 52224
    s_cselect_b32 s56, 52224, 0
    s_sub_u32 s77, s77, s56
    s_lshl_b32 s56, s55, 10
    s_add_u32 s56, s56, s78
    s_xor_b32 s57, s4, 393216
    s_add_u32 m0, s56, 52224
    s_nop 0
    buffer_load_dwordx4 v18, s[12:15], s57 offen lds
    s_add_u32 m0, s56, 56320
    s_add_u32 s57, s57, 524288
    buffer_load_dwordx4 v18, s[12:15], s57 offen lds
    s_add_u32 m0, s56, 60416
    s_add_u32 s57, s57, 524288
    buffer_load_dwordx4 v18, s[12:15], s57 offen lds
    s_add_u32 m0, s56, 64512
    s_add_u32 s57, s57, 524288
    buffer_load_dwordx4 v18, s[12:15], s57 offen lds
    s_add_u32 m0, s56, 68608
    s_add_u32 s57, s57, 524288
    buffer_load_dwordx4 v18, s[12:15], s57 offen lds
    s_add_u32 s78, s78, 20480
    s_cmp_ge_u32 s78, 102400
    s_cselect_b32 s78, 0, s78
    s_waitcnt vmcnt(9)
    s_barrier
    s_lshl_b32 s56, s55, 10
    s_add_u32 s56, s56, s78
    s_xor_b32 s57, s4, 425984
    s_add_u32 m0, s56, 52224
    s_nop 0
    buffer_load_dwordx4 v18, s[12:15], s57 offen lds
    s_add_u32 m0, s56, 56320
    s_add_u32 s57, s57, 524288
    buffer_load_dwordx4 v18, s[12:15], s57 offen lds
    s_add_u32 m0, s56, 60416
    s_add_u32 s57, s57, 524288
    buffer_load_dwordx4 v18, s[12:15], s57 offen lds
    s_add_u32 m0, s56, 64512
    s_add_u32 s57, s57, 524288
    buffer_load_dwordx4 v18, s[12:15], s57 offen lds
    s_add_u32 m0, s56, 68608
    s_add_u32 s57, s57, 524288
    buffer_load_dwordx4 v18, s[12:15], s57 offen lds
    s_add_u32 s78, s78, 20480
    s_cmp_ge_u32 s78, 102400
    s_cselect_b32 s78, 0, s78
    s_xor_b32 s82, s3, 896
    s_lshl_b32 s56, s55, 10
    s_add_u32 s56, s56, s77
    s_add_u32 m0, s56, 0
    s_nop 0
    buffer_load_dwordx4 v8, s[8:11], s82 offen sc1 lds
    s_add_u32 m0, s56, 4096
    s_nop 0
    buffer_load_dwordx4 v9, s[8:11], s82 offen sc1 lds
    s_add_u32 m0, s56, 8192
    s_nop 0
    buffer_load_dwordx4 v10, s[8:11], s82 offen sc1 lds
    s_add_u32 m0, s56, 12288
    s_nop 0
    buffer_load_dwordx4 v11, s[8:11], s82 offen sc1 lds
    s_cmp_lt_u32 s55, 1
    s_cbranch_scc0 Lx_68
    s_add_u32 m0, s56, 16384
    s_nop 0
    buffer_load_dwordx4 v12, s[8:11], s82 offen sc1 lds
Lx_68:
    s_add_u32 s77, s77, 34816
    s_cmp_ge_u32 s77, 52224
    s_cselect_b32 s56, 52224, 0
    s_sub_u32 s77, s77, s56
    s_lshl_b32 s56, s55, 10
    s_add_u32 s56, s56, s78
    s_xor_b32 s57, s4, 458752
    s_add_u32 m0, s56, 52224
    s_nop 0
    buffer_load_dwordx4 v18, s[12:15], s57 offen lds
    s_add_u32 m0, s56, 56320
    s_add_u32 s57, s57, 524288
    buffer_load_dwordx4 v18, s[12:15], s57 offen lds
    s_add_u32 m0, s56, 60416
    s_add_u32 s57, s57, 524288
    buffer_load_dwordx4 v18, s[12:15], s57 offen lds
    s_add_u32 m0, s56, 64512
    s_add_u32 s57, s57, 524288
    buffer_load_dwordx4 v18, s[12:15], s57 offen lds
    s_add_u32 m0, s56, 68608
    s_add_u32 s57, s57, 524288
    buffer_load_dwordx4 v18, s[12:15], s57 offen lds
    s_add_u32 s78, s78, 20480
    s_cmp_ge_u32 s78, 102400
    s_cselect_b32 s78, 0, s78
    v_lshlrev_b32 v28, 2, v0
    v_add_u32 v28, 15945728, v28
    v_add_u32 v29, 256, v28
    v_and_b32 v30, 31, v0
    v_lshlrev_b32 v30, 3, v30
    v_add_u32 v30, 15949824, v30
    s_cmp_eq_u32 s55, 3
    s_cbranch_scc0 Lo_69
    buffer_load_dword v24, v28, s[16:19], 0 offen sc1
    buffer_load_dword v25, v29, s[16:19], 0 offen sc1
    buffer_load_dwordx2 v[26:27], v30, s[16:19], 0 offen sc1
Lo_69:
    s_waitcnt vmcnt(9)
    s_barrier
    s_lshl_b32 s56, s55, 10
    s_add_u32 s56, s56, s78
    s_xor_b32 s57, s4, 491520
    s_add_u32 m0, s56, 52224
    s_nop 0
    buffer_load_dwordx4 v18, s[12:15], s57 offen lds
    s_add_u32 m0, s56, 56320
    s_add_u32 s57, s57, 524288
    buffer_load_dwordx4 v18, s[12:15], s57 offen lds
    s_add_u32 m0, s56, 60416
    s_add_u32 s57, s57, 524288
    buffer_load_dwordx4 v18, s[12:15], s57 offen lds
    s_add_u32 m0, s56, 64512
    s_add_u32 s57, s57, 524288
    buffer_load_dwordx4 v18, s[12:15], s57 offen lds
    s_add_u32 m0, s56, 68608
    s_add_u32 s57, s57, 524288
    buffer_load_dwordx4 v18, s[12:15], s57 offen lds
    s_add_u32 s78, s78, 20480
    s_cmp_ge_u32 s78, 102400
    s_cselect_b32 s78, 0, s78
    s_waitcnt vmcnt(0)
    s_barrier
    s_cmp_eq_u32 s55, 3
    s_cbranch_scc0 Lo_70
    s_waitcnt vmcnt(5)
    v_cmp_ne_u32 vcc, s86, v24
    s_cbranch_vccz Lc_71
    s_mov_b32 s72, 0
Lp_72:
    buffer_load_dword v24, v28, s[16:19], 0 offen sc1
    s_add_u32 s72, s72, 1
    s_cmp_ge_u32 s72, 40000
    s_cbranch_scc1 Lp_73
    s_waitcnt vmcnt(0)
    v_cmp_ne_u32 vcc, s86, v24
    s_cbranch_vccnz Lp_72
Lp_73:
    s_waitcnt vmcnt(0)
Lc_71:
    v_cmp_ne_u32 vcc, s86, v25
    s_cbranch_vccz Lc_74
    s_mov_b32 s72, 0
Lp_75:
    buffer_load_dword v25, v29, s[16:19], 0 offen sc1
    s_add_u32 s72, s72, 1
    s_cmp_ge_u32 s72, 40000
    s_cbranch_scc1 Lp_76
    s_waitcnt vmcnt(0)
    v_cmp_ne_u32 vcc, s86, v25
    s_cbranch_vccnz Lp_75
Lp_76:
    s_waitcnt vmcnt(0)
Lc_74:
    v_cmp_ne_u32 vcc, s86, v26
    s_cbranch_vccz Lc_77
    s_mov_b32 s72, 0
Lp_78:
    buffer_load_dwordx2 v[26:27], v30, s[16:19], 0 offen sc1
    s_add_u32 s72, s72, 1
    s_cmp_ge_u32 s72, 40000
    s_cbranch_scc1 Lp_79
    s_waitcnt vmcnt(0)
    v_cmp_ne_u32 vcc, s86, v26
    s_cbranch_vccnz Lp_78
Lp_79:
    s_waitcnt vmcnt(0)
Lc_77:
    v_cmp_ne_u32 vcc, 0, v27
    s_nop 4
    s_cmp_lg_u64 vcc, 0
    s_cselect_b32 s85, 1, 0
    v_mov_b32 v2, 163592
    v_mov_b32 v3, s85
    ds_write_b32 v2, v3
    s_waitcnt lgkmcnt(0)
Lo_70:
    s_barrier
    v_mov_b32 v2, 163592
    ds_read_b32 v3, v2
    s_waitcnt lgkmcnt(0)
    v_readfirstlane_b32 s85, v3
    s_and_b32 s56, s49, 3
    s_lshl_b32 s56, s56, 17
    s_add_u32 s56, s56, 14680064
    s_lshl_b32 s57, s55, 15
    s_add_u32 s56, s56, s57
    v_lshlrev_b32 v5, 4, v0
    s_add_u32 m0, s57, 0
    s_add_u32 s58, s56, 0
    buffer_load_dwordx4 v5, s[16:19], s58 offen  lds
    s_add_u32 m0, s57, 16384
    s_add_u32 s58, s56, 16384
    buffer_load_dwordx4 v5, s[16:19], s58 offen  lds
    s_add_u32 m0, s57, 1024
    s_add_u32 s58, s56, 1024
    buffer_load_dwordx4 v5, s[16:19], s58 offen  lds
    s_add_u32 m0, s57, 17408
    s_add_u32 s58, s56, 17408
    buffer_load_dwordx4 v5, s[16:19], s58 offen  lds
    s_add_u32 m0, s57, 2048
    s_add_u32 s58, s56, 2048
    buffer_load_dwordx4 v5, s[16:19], s58 offen  lds
    s_add_u32 m0, s57, 18432
    s_add_u32 s58, s56, 18432
    buffer_load_dwordx4 v5, s[16:19], s58 offen  lds
    s_add_u32 m0, s57, 3072
    s_add_u32 s58, s56, 3072
    buffer_load_dwordx4 v5, s[16:19], s58 offen  lds
    s_add_u32 m0, s57, 19456
    s_add_u32 s58, s56, 19456
    buffer_load_dwordx4 v5, s[16:19], s58 offen  lds
    s_add_u32 m0, s57, 4096
    s_add_u32 s58, s56, 4096
    buffer_load_dwordx4 v5, s[16:19], s58 offen  lds
    s_add_u32 m0, s57, 20480
    s_add_u32 s58, s56, 20480
    buffer_load_dwordx4 v5, s[16:19], s58 offen  lds
    s_add_u32 m0, s57, 5120
    s_add_u32 s58, s56, 5120
    buffer_load_dwordx4 v5, s[16:19], s58 offen  lds
    s_add_u32 m0, s57, 21504
    s_add_u32 s58, s56, 21504
    buffer_load_dwordx4 v5, s[16:19], s58 offen  lds
    s_add_u32 m0, s57, 6144
    s_add_u32 s58, s56, 6144
    buffer_load_dwordx4 v5, s[16:19], s58 offen  lds
    s_add_u32 m0, s57, 22528
    s_add_u32 s58, s56, 22528
    buffer_load_dwordx4 v5, s[16:19], s58 offen  lds
    s_add_u32 m0, s57, 7168
    s_add_u32 s58, s56, 7168
    buffer_load_dwordx4 v5, s[16:19], s58 offen  lds
    s_add_u32 m0, s57, 23552
    s_add_u32 s58, s56, 23552
    buffer_load_dwordx4 v5, s[16:19], s58 offen  lds
    s_add_u32 m0, s57, 8192
    s_add_u32 s58, s56, 8192
    buffer_load_dwordx4 v5, s[16:19], s58 offen  lds
    s_add_u32 m0, s57, 24576
    s_add_u32 s58, s56, 24576
    buffer_load_dwordx4 v5, s[16:19], s58 offen  lds
    s_add_u32 m0, s57, 9216
    s_add_u32 s58, s56, 9216
    buffer_load_dwordx4 v5, s[16:19], s58 offen  lds
    s_add_u32 m0, s57, 25600
    s_add_u32 s58, s56, 25600
    buffer_load_dwordx4 v5, s[16:19], s58 offen  lds
    s_add_u32 m0, s57, 10240
    s_add_u32 s58, s56, 10240
    buffer_load_dwordx4 v5, s[16:19], s58 offen  lds
    s_add_u32 m0, s57, 26624
    s_add_u32 s58, s56, 26624
    buffer_load_dwordx4 v5, s[16:19], s58 offen  lds
    s_add_u32 m0, s57, 11264
    s_add_u32 s58, s56, 11264
    buffer_load_dwordx4 v5, s[16:19], s58 offen  lds
    s_add_u32 m0, s57, 27648
    s_add_u32 s58, s56, 27648
    buffer_load_dwordx4 v5, s[16:19], s58 offen  lds
    s_lshr_b32 s56, s49, 3
    s_lshl_b32 s56, s56, 7
    s_lshl_b32 s57, s48, 9
    s_add_u32 s56, s56, s57
    s_add_u32 s56, s56, 15937536
    v_and_b32 v6, 31, v0
    v_lshlrev_b32 v6, 2, v6
    v_add_u32 v6, s56, v6
    v_lshrrev_b32 v2, 3, v0
    s_lshl_b32 s56, s55, 3
    v_add_u32 v2, s56, v2
    v_and_b32 v3, 7, v0
    v_lshlrev_b32 v4, 1, v2
    v_and_b32 v4, 28, v4
    s_mov_b32 s58, 0x42764210
    v_lshrrev_b32 v4, v4, s58
    v_and_b32 v4, 7, v4
    v_xor_b32 v4, v4, v3
    v_lshlrev_b32 v4, 4, v4
    v_lshl_add_u32 v4, v2, 10, v4
    s_waitcnt vmcnt(0) lgkmcnt(0)
    s_barrier
    s_mov_b32 s72, 0
Lp_80:
    buffer_load_dword v7, v6, s[16:19], 0 offen sc1
    s_add_u32 s72, s72, 1
    s_cmp_ge_u32 s72, 40000
    s_cbranch_scc1 Lp_81
    s_waitcnt vmcnt(0)
    v_cmp_ne_u32 vcc, s86, v7
    s_cbranch_vccnz Lp_80
Lp_81:
    s_waitcnt vmcnt(0)
    s_lshr_b32 s56, s49, 2
    s_lshl_b32 s56, s56, 15
    s_lshl_b32 s57, s48, 18
    s_add_u32 s56, s56, s57
    s_add_u32 s56, s56, 5242880
    s_lshl_b32 s57, s55, 10
    s_mov_b32 s64, s56
    s_mov_b32 s65, s57
    s_add_u32 m0, s65, 131072
    s_add_u32 s58, s64, 0
    buffer_load_dwordx4 v4, s[16:19], s58 offen sc1 lds
    s_add_u32 m0, s65, 135168
    s_add_u32 s58, s64, 128
    buffer_load_dwordx4 v4, s[16:19], s58 offen sc1 lds
    s_add_u32 m0, s65, 139264
    s_add_u32 s58, s64, 256
    buffer_load_dwordx4 v4, s[16:19], s58 offen sc1 lds
    s_add_u32 m0, s65, 143360
    s_add_u32 s58, s64, 384
    buffer_load_dwordx4 v4, s[16:19], s58 offen sc1 lds
    s_waitcnt vmcnt(2) lgkmcnt(0)
    s_barrier
    s_add_u32 m0, s65, 147456
    s_add_u32 s58, s64, 512
    buffer_load_dwordx4 v4, s[16:19], s58 offen sc1 lds
    s_add_u32 m0, s65, 151552
    s_add_u32 s58, s64, 640
    buffer_load_dwordx4 v4, s[16:19], s58 offen sc1 lds
    s_add_u32 m0, s65, 155648
    s_add_u32 s58, s64, 768
    buffer_load_dwordx4 v4, s[16:19], s58 offen sc1 lds
    s_add_u32 m0, s65, 159744
    s_add_u32 s58, s64, 896
    buffer_load_dwordx4 v4, s[16:19], s58 offen sc1 lds
    s_and_b32 s56, s49, 3
    s_lshl_b32 s56, s56, 17
    s_add_u32 s56, s56, 14680064
    s_lshl_b32 s57, s55, 15
    s_add_u32 s56, s56, s57
    v_lshlrev_b32 v5, 4, v0
    s_add_u32 m0, s57, 12288
    s_add_u32 s58, s56, 12288
    buffer_load_dwordx4 v5, s[16:19], s58 offen  lds
    s_add_u32 m0, s57, 28672
    s_add_u32 s58, s56, 28672
    buffer_load_dwordx4 v5, s[16:19], s58 offen  lds
    s_add_u32 m0, s57, 13312
    s_add_u32 s58, s56, 13312
    buffer_load_dwordx4 v5, s[16:19], s58 offen  lds
    s_add_u32 m0, s57, 29696
    s_add_u32 s58, s56, 29696
    buffer_load_dwordx4 v5, s[16:19], s58 offen  lds
    s_add_u32 m0, s57, 14336
    s_add_u32 s58, s56, 14336
    buffer_load_dwordx4 v5, s[16:19], s58 offen  lds
    s_add_u32 m0, s57, 30720
    s_add_u32 s58, s56, 30720
    buffer_load_dwordx4 v5, s[16:19], s58 offen  lds
    s_add_u32 m0, s57, 15360
    s_add_u32 s58, s56, 15360
    buffer_load_dwordx4 v5, s[16:19], s58 offen  lds
    s_add_u32 m0, s57, 31744
    s_add_u32 s58, s56, 31744
    buffer_load_dwordx4 v5, s[16:19], s58 offen  lds
    s_waitcnt vmcnt(12)
    s_barrier
    s_lshl_b32 s56, s49, 14
    s_lshl_b32 s57, s55, 12
    s_add_u32 s56, s56, s57
    s_add_u32 s56, s56, 13631488
    v_lshlrev_b32 v5, 4, v0
    buffer_load_dwordx4 v[200:203], v5, s[16:19], s56 offen offset:0
    buffer_load_dwordx4 v[200:203], v5, s[16:19], s56 offen offset:1024
    buffer_load_dwordx4 v[200:203], v5, s[16:19], s56 offen offset:2048
    buffer_load_dwordx4 v[200:203], v5, s[16:19], s56 offen offset:3072
    s_waitcnt vmcnt(14)
    s_barrier
    s_waitcnt vmcnt(4)
    s_barrier
    s_barrier
    s_mov_b32 s56, 15728640
    s_cmp_eq_u32 s85, 0
    s_cselect_b32 s56, s56, 15794176
    s_lshl_b32 s57, s50, 14
    s_add_u32 s56, s56, s57
    s_lshl_b32 s57, s55, 8
    s_add_u32 s56, s56, s57
    s_lshl_b32 s57, s55, 12
    v_lshrrev_b32 v2, 4, v0
    v_and_b32 v3, 15, v0
    v_lshlrev_b32 v3, 4, v3
    v_lshl_add_u32 v4, v2, 10, v3
    s_add_u32 m0, s57, 81920
    s_nop 0
    buffer_load_dwordx4 v4, s[16:19], s56 offen sc1 lds
    s_add_u32 s56, s56, 4096
    s_add_u32 m0, s57, 82944
    s_nop 0
    buffer_load_dwordx4 v4, s[16:19], s56 offen sc1 lds
    s_add_u32 s56, s56, 4096
    s_add_u32 m0, s57, 83968
    s_nop 0
    buffer_load_dwordx4 v4, s[16:19], s56 offen sc1 lds
    s_add_u32 s56, s56, 4096
    s_add_u32 m0, s57, 84992
    s_nop 0
    buffer_load_dwordx4 v4, s[16:19], s56 offen sc1 lds
    s_add_u32 s56, s56, 4096
    v_lshrrev_b32 v2, 3, v0
    v_and_b32 v3, 7, v0
    v_and_b32 v5, 6, v2
    v_xor_b32 v3, v3, v5
    v_lshlrev_b32 v3, 4, v3
    v_lshl_add_u32 v5, v2, 11, v3
    s_lshr_b32 s56, s49, 2
    s_lshl_b32 s56, s56, 6
    s_lshl_b32 s58, s48, 9
    s_add_u32 s56, s56, s58
    s_add_u32 s56, s56, 15941632
    v_and_b32 v6, 15, v0
    v_lshlrev_b32 v6, 2, v6
    v_add_u32 v9, s56, v6
    s_waitcnt vmcnt(0)
    v_and_b32 v6, 7, v0
    v_lshlrev_b32 v6, 4, v6
    s_lshl_b32 s56, s55, 12
    s_add_u32 s56, s56, 81920
    v_add_u32 v6, s56, v6
    ds_read_b128 v[128:131], v6 offset:0
    ds_read_b128 v[132:135], v6 offset:128
    ds_read_b128 v[136:139], v6 offset:256
    ds_read_b128 v[140:143], v6 offset:384
    ds_read_b128 v[144:147], v6 offset:512
    ds_read_b128 v[148:151], v6 offset:640
    ds_read_b128 v[152:155], v6 offset:768
    ds_read_b128 v[156:159], v6 offset:896
    s_waitcnt lgkmcnt(0)
    ds_read_b128 v[160:163], v6 offset:1024
    ds_read_b128 v[164:167], v6 offset:1152
    ds_read_b128 v[168:171], v6 offset:1280
    ds_read_b128 v[172:175], v6 offset:1408
    ds_read_b128 v[176:179], v6 offset:1536
    ds_read_b128 v[180:183], v6 offset:1664
    ds_read_b128 v[184:187], v6 offset:1792
    ds_read_b128 v[188:191], v6 offset:1920
    s_waitcnt lgkmcnt(0)
    ds_read_b128 v[192:195], v6 offset:2048
    ds_read_b128 v[196:199], v6 offset:2176
    ds_read_b128 v[200:203], v6 offset:2304
    ds_read_b128 v[204:207], v6 offset:2432
    ds_read_b128 v[208:211], v6 offset:2560
    ds_read_b128 v[212:215], v6 offset:2688
    ds_read_b128 v[216:219], v6 offset:2816
    ds_read_b128 v[220:223], v6 offset:2944
    s_waitcnt lgkmcnt(0)
    ds_read_b128 v[224:227], v6 offset:3072
    ds_read_b128 v[228:231], v6 offset:3200
    ds_read_b128 v[232:235], v6 offset:3328
    ds_read_b128 v[236:239], v6 offset:3456
    ds_read_b128 v[240:243], v6 offset:3584
    ds_read_b128 v[244:247], v6 offset:3712
    ds_read_b128 v[248:251], v6 offset:3840
    ds_read_b128 v[252:255], v6 offset:3968
    s_waitcnt lgkmcnt(0)
    s_mov_b32 s72, 0
Lp_82:
    buffer_load_dword v14, v9, s[16:19], 0 offen sc1
    s_add_u32 s72, s72, 1
    s_cmp_ge_u32 s72, 40000
    s_cbranch_scc1 Lp_83
    s_waitcnt vmcnt(0)
    v_cmp_ne_u32 vcc, s86, v14
    s_cbranch_vccnz Lp_82
Lp_83:
    s_waitcnt vmcnt(0)
    s_lshl_b32 s56, s48, 19
    s_lshl_b32 s57, s49, 14
    s_add_u32 s56, s56, s57
    s_add_u32 s56, s56, 8388608
    s_lshl_b32 s57, s55, 7
    s_add_u32 s56, s56, s57
    s_lshl_b32 s57, s55, 10
    s_add_u32 m0, s57, 65536
    s_nop 0
    buffer_load_dwordx4 v5, s[16:19], s56 offen sc1 lds
    s_add_u32 s56, s56, 512
    s_add_u32 m0, s57, 69632
    s_nop 0
    buffer_load_dwordx4 v5, s[16:19], s56 offen sc1 lds
    s_add_u32 s56, s56, 512
    s_add_u32 m0, s57, 73728
    s_nop 0
    buffer_load_dwordx4 v5, s[16:19], s56 offen sc1 lds
    s_add_u32 s56, s56, 512
    s_add_u32 m0, s57, 77824
    s_nop 0
    buffer_load_dwordx4 v5, s[16:19], s56 offen sc1 lds
    s_add_u32 s56, s56, 512
    v_lshrrev_b32 v2, 3, v0
    v_and_b32 v5, 6, v2
    s_lshl_b32 s56, s55, 1
    v_xor_b32 v5, s56, v5
    v_lshlrev_b32 v5, 4, v5
    v_lshl_add_u32 v7, v2, 7, v5
    v_add_u32 v7, 65536, v7
    s_lshl_b32 s56, s55, 10
    v_lshlrev_b32 v8, 4, v0
    v_add_u32 v8, s56, v8
    v_mov_b32 v10, 1.0
    v_mov_b32 v11, 1.0
    v_mov_b32 v12, -2.0
    v_mov_b32 v13, -2.0
    s_waitcnt vmcnt(0)
    s_barrier
    s_cmp_eq_u32 s85, 0
    s_cbranch_scc0 Lu_84
    ds_read_b128 v[16:19], v7 offset:0
    ds_read_b128 v[20:23], v7 offset:16
    ds_read_b128 v[24:27], v7 offset:1024
    ds_read_b128 v[28:31], v7 offset:1040
    s_waitcnt lgkmcnt(2)
    v_fma_f32 v32, v16, v128, 1.0
    v_fma_f32 v33, v17, v129, 1.0
    v_fma_f32 v34, v18, v130, 1.0
    v_fma_f32 v35, v19, v131, 1.0
    v_fma_f32 v36, v20, v132, 1.0
    v_fma_f32 v37, v21, v133, 1.0
    v_fma_f32 v38, v22, v134, 1.0
    v_fma_f32 v39, v23, v135, 1.0
    v_rcp_f32 v32, v32
    v_rcp_f32 v33, v33
    v_rcp_f32 v34, v34
    v_rcp_f32 v35, v35
    v_rcp_f32 v36, v36
    v_rcp_f32 v37, v37
    v_rcp_f32 v38, v38
    v_rcp_f32 v39, v39
    v_fma_f32 v32, v32, -2.0, 1.0
    v_fma_f32 v33, v33, -2.0, 1.0
    v_fma_f32 v34, v34, -2.0, 1.0
    v_fma_f32 v35, v35, -2.0, 1.0
    v_fma_f32 v36, v36, -2.0, 1.0
    v_fma_f32 v37, v37, -2.0, 1.0
    v_fma_f32 v38, v38, -2.0, 1.0
    v_fma_f32 v39, v39, -2.0, 1.0
    v_cvt_pk_bf16_f32 v40, v32, v33
    v_cvt_pk_bf16_f32 v41, v34, v35
    v_cvt_pk_bf16_f32 v42, v36, v37
    v_cvt_pk_bf16_f32 v43, v38, v39
    ds_write_b128 v8, v[40:43] offset:0
    ds_read_b128 v[16:19], v7 offset:2048
    ds_read_b128 v[20:23], v7 offset:2064
    s_waitcnt lgkmcnt(3)
    v_fma_f32 v32, v24, v136, 1.0
    v_fma_f32 v33, v25, v137, 1.0
    v_fma_f32 v34, v26, v138, 1.0
    v_fma_f32 v35, v27, v139, 1.0
    v_fma_f32 v36, v28, v140, 1.0
    v_fma_f32 v37, v29, v141, 1.0
    v_fma_f32 v38, v30, v142, 1.0
    v_fma_f32 v39, v31, v143, 1.0
    v_rcp_f32 v32, v32
    v_rcp_f32 v33, v33
    v_rcp_f32 v34, v34
    v_rcp_f32 v35, v35
    v_rcp_f32 v36, v36
    v_rcp_f32 v37, v37
    v_rcp_f32 v38, v38
    v_rcp_f32 v39, v39
    v_fma_f32 v32, v32, -2.0, 1.0
    v_fma_f32 v33, v33, -2.0, 1.0
    v_fma_f32 v34, v34, -2.0, 1.0
    v_fma_f32 v35, v35, -2.0, 1.0
    v_fma_f32 v36, v36, -2.0, 1.0
    v_fma_f32 v37, v37, -2.0, 1.0
    v_fma_f32 v38, v38, -2.0, 1.0
    v_fma_f32 v39, v39, -2.0, 1.0
    v_cvt_pk_bf16_f32 v44, v32, v33
    v_cvt_pk_bf16_f32 v45, v34, v35
    v_cvt_pk_bf16_f32 v46, v36, v37
    v_cvt_pk_bf16_f32 v47, v38, v39
    ds_write_b128 v8, v[44:47] offset:4096
    s_waitcnt lgkmcnt(0)
    s_barrier
    ds_read_b128 v[24:27], v7 offset:3072
    ds_read_b128 v[28:31], v7 offset:3088
    s_waitcnt lgkmcnt(2)
    v_fma_f32 v32, v16, v144, 1.0
    v_fma_f32 v33, v17, v145, 1.0
    v_fma_f32 v34, v18, v146, 1.0
    v_fma_f32 v35, v19, v147, 1.0
    v_fma_f32 v36, v20, v148, 1.0
    v_fma_f32 v37, v21, v149, 1.0
    v_fma_f32 v38, v22, v150, 1.0
    v_fma_f32 v39, v23, v151, 1.0
    v_rcp_f32 v32, v32
    v_rcp_f32 v33, v33
    v_rcp_f32 v34, v34
    v_rcp_f32 v35, v35
    v_rcp_f32 v36, v36
    v_rcp_f32 v37, v37
    v_rcp_f32 v38, v38
    v_rcp_f32 v39, v39
    v_fma_f32 v32, v32, -2.0, 1.0
    v_fma_f32 v33, v33, -2.0, 1.0
    v_fma_f32 v34, v34, -2.0, 1.0
    v_fma_f32 v35, v35, -2.0, 1.0
    v_fma_f32 v36, v36, -2.0, 1.0
    v_fma_f32 v37, v37, -2.0, 1.0
    v_fma_f32 v38, v38, -2.0, 1.0
    v_fma_f32 v39, v39, -2.0, 1.0
    v_cvt_pk_bf16_f32 v40, v32, v33
    v_cvt_pk_bf16_f32 v41, v34, v35
    v_cvt_pk_bf16_f32 v42, v36, v37
    v_cvt_pk_bf16_f32 v43, v38, v39
    ds_write_b128 v8, v[40:43] offset:8192
    ds_read_b128 v[16:19], v7 offset:4096
    ds_read_b128 v[20:23], v7 offset:4112
    s_waitcnt lgkmcnt(3)
    v_fma_f32 v32, v24, v152, 1.0
    v_fma_f32 v33, v25, v153, 1.0
    v_fma_f32 v34, v26, v154, 1.0
    v_fma_f32 v35, v27, v155, 1.0
    v_fma_f32 v36, v28, v156, 1.0
    v_fma_f32 v37, v29, v157, 1.0
    v_fma_f32 v38, v30, v158, 1.0
    v_fma_f32 v39, v31, v159, 1.0
    v_rcp_f32 v32, v32
    v_rcp_f32 v33, v33
    v_rcp_f32 v34, v34
    v_rcp_f32 v35, v35
    v_rcp_f32 v36, v36
    v_rcp_f32 v37, v37
    v_rcp_f32 v38, v38
    v_rcp_f32 v39, v39
    v_fma_f32 v32, v32, -2.0, 1.0
    v_fma_f32 v33, v33, -2.0, 1.0
    v_fma_f32 v34, v34, -2.0, 1.0
    v_fma_f32 v35, v35, -2.0, 1.0
    v_fma_f32 v36, v36, -2.0, 1.0
    v_fma_f32 v37, v37, -2.0, 1.0
    v_fma_f32 v38, v38, -2.0, 1.0
    v_fma_f32 v39, v39, -2.0, 1.0
    v_cvt_pk_bf16_f32 v44, v32, v33
    v_cvt_pk_bf16_f32 v45, v34, v35
    v_cvt_pk_bf16_f32 v46, v36, v37
    v_cvt_pk_bf16_f32 v47, v38, v39
    ds_write_b128 v8, v[44:47] offset:12288
    ds_read_b128 v[24:27], v7 offset:5120
    ds_read_b128 v[28:31], v7 offset:5136
    s_waitcnt lgkmcnt(3)
    s_barrier
    v_fma_f32 v32, v16, v160, 1.0
    v_fma_f32 v33, v17, v161, 1.0
    v_fma_f32 v34, v18, v162, 1.0
    v_fma_f32 v35, v19, v163, 1.0
    v_fma_f32 v36, v20, v164, 1.0
    v_fma_f32 v37, v21, v165, 1.0
    v_fma_f32 v38, v22, v166, 1.0
    v_fma_f32 v39, v23, v167, 1.0
    v_rcp_f32 v32, v32
    v_rcp_f32 v33, v33
    v_rcp_f32 v34, v34
    v_rcp_f32 v35, v35
    v_rcp_f32 v36, v36
    v_rcp_f32 v37, v37
    v_rcp_f32 v38, v38
    v_rcp_f32 v39, v39
    v_fma_f32 v32, v32, -2.0, 1.0
    v_fma_f32 v33, v33, -2.0, 1.0
    v_fma_f32 v34, v34, -2.0, 1.0
    v_fma_f32 v35, v35, -2.0, 1.0
    v_fma_f32 v36, v36, -2.0, 1.0
    v_fma_f32 v37, v37, -2.0, 1.0
    v_fma_f32 v38, v38, -2.0, 1.0
    v_fma_f32 v39, v39, -2.0, 1.0
    v_cvt_pk_bf16_f32 v40, v32, v33
    v_cvt_pk_bf16_f32 v41, v34, v35
    v_cvt_pk_bf16_f32 v42, v36, v37
    v_cvt_pk_bf16_f32 v43, v38, v39
    ds_write_b128 v8, v[40:43] offset:16384
    ds_read_b128 v[16:19], v7 offset:6144
    ds_read_b128 v[20:23], v7 offset:6160
    s_waitcnt lgkmcnt(3)
    s_barrier
    v_fma_f32 v32, v24, v168, 1.0
    v_fma_f32 v33, v25, v169, 1.0
    v_fma_f32 v34, v26, v170, 1.0
    v_fma_f32 v35, v27, v171, 1.0
    v_fma_f32 v36, v28, v172, 1.0
    v_fma_f32 v37, v29, v173, 1.0
    v_fma_f32 v38, v30, v174, 1.0
    v_fma_f32 v39, v31, v175, 1.0
    v_rcp_f32 v32, v32
    v_rcp_f32 v33, v33
    v_rcp_f32 v34, v34
    v_rcp_f32 v35, v35
    v_rcp_f32 v36, v36
    v_rcp_f32 v37, v37
    v_rcp_f32 v38, v38
    v_rcp_f32 v39, v39
    v_fma_f32 v32, v32, -2.0, 1.0
    v_fma_f32 v33, v33, -2.0, 1.0
    v_fma_f32 v34, v34, -2.0, 1.0
    v_fma_f32 v35, v35, -2.0, 1.0
    v_fma_f32 v36, v36, -2.0, 1.0
    v_fma_f32 v37, v37, -2.0, 1.0
    v_fma_f32 v38, v38, -2.0, 1.0
    v_fma_f32 v39, v39, -2.0, 1.0
    v_cvt_pk_bf16_f32 v44, v32, v33
    v_cvt_pk_bf16_f32 v45, v34, v35
    v_cvt_pk_bf16_f32 v46, v36, v37
    v_cvt_pk_bf16_f32 v47, v38, v39
    ds_write_b128 v8, v[44:47] offset:20480
    ds_read_b128 v[24:27], v7 offset:7168
    ds_read_b128 v[28:31], v7 offset:7184
    s_waitcnt lgkmcnt(3)
    s_barrier
    v_fma_f32 v32, v16, v176, 1.0
    v_fma_f32 v33, v17, v177, 1.0
    v_fma_f32 v34, v18, v178, 1.0
    v_fma_f32 v35, v19, v179, 1.0
    v_fma_f32 v36, v20, v180, 1.0
    v_fma_f32 v37, v21, v181, 1.0
    v_fma_f32 v38, v22, v182, 1.0
    v_fma_f32 v39, v23, v183, 1.0
    v_rcp_f32 v32, v32
    v_rcp_f32 v33, v33
    v_rcp_f32 v34, v34
    v_rcp_f32 v35, v35
    v_rcp_f32 v36, v36
    v_rcp_f32 v37, v37
    v_rcp_f32 v38, v38
    v_rcp_f32 v39, v39
    v_fma_f32 v32, v32, -2.0, 1.0
    v_fma_f32 v33, v33, -2.0, 1.0
    v_fma_f32 v34, v34, -2.0, 1.0
    v_fma_f32 v35, v35, -2.0, 1.0
    v_fma_f32 v36, v36, -2.0, 1.0
    v_fma_f32 v37, v37, -2.0, 1.0
    v_fma_f32 v38, v38, -2.0, 1.0
    v_fma_f32 v39, v39, -2.0, 1.0
    v_cvt_pk_bf16_f32 v40, v32, v33
    v_cvt_pk_bf16_f32 v41, v34, v35
    v_cvt_pk_bf16_f32 v42, v36, v37
    v_cvt_pk_bf16_f32 v43, v38, v39
    ds_write_b128 v8, v[40:43] offset:24576
    ds_read_b128 v[16:19], v7 offset:8192
    ds_read_b128 v[20:23], v7 offset:8208
    s_waitcnt lgkmcnt(3)
    s_barrier
    v_fma_f32 v32, v24, v184, 1.0
    v_fma_f32 v33, v25, v185, 1.0
    v_fma_f32 v34, v26, v186, 1.0
    v_fma_f32 v35, v27, v187, 1.0
    v_fma_f32 v36, v28, v188, 1.0
    v_fma_f32 v37, v29, v189, 1.0
    v_fma_f32 v38, v30, v190, 1.0
    v_fma_f32 v39, v31, v191, 1.0
    v_rcp_f32 v32, v32
    v_rcp_f32 v33, v33
    v_rcp_f32 v34, v34
    v_rcp_f32 v35, v35
    v_rcp_f32 v36, v36
    v_rcp_f32 v37, v37
    v_rcp_f32 v38, v38
    v_rcp_f32 v39, v39
    v_fma_f32 v32, v32, -2.0, 1.0
    v_fma_f32 v33, v33, -2.0, 1.0
    v_fma_f32 v34, v34, -2.0, 1.0
    v_fma_f32 v35, v35, -2.0, 1.0
    v_fma_f32 v36, v36, -2.0, 1.0
    v_fma_f32 v37, v37, -2.0, 1.0
    v_fma_f32 v38, v38, -2.0, 1.0
    v_fma_f32 v39, v39, -2.0, 1.0
    v_cvt_pk_bf16_f32 v44, v32, v33
    v_cvt_pk_bf16_f32 v45, v34, v35
    v_cvt_pk_bf16_f32 v46, v36, v37
    v_cvt_pk_bf16_f32 v47, v38, v39
    ds_write_b128 v8, v[44:47] offset:28672
    ds_read_b128 v[24:27], v7 offset:9216
    ds_read_b128 v[28:31], v7 offset:9232
    s_waitcnt lgkmcnt(3)
    s_barrier
    v_fma_f32 v32, v16, v192, 1.0
    v_fma_f32 v33, v17, v193, 1.0
    v_fma_f32 v34, v18, v194, 1.0
    v_fma_f32 v35, v19, v195, 1.0
    v_fma_f32 v36, v20, v196, 1.0
    v_fma_f32 v37, v21, v197, 1.0
    v_fma_f32 v38, v22, v198, 1.0
    v_fma_f32 v39, v23, v199, 1.0
    v_rcp_f32 v32, v32
    v_rcp_f32 v33, v33
    v_rcp_f32 v34, v34
    v_rcp_f32 v35, v35
    v_rcp_f32 v36, v36
    v_rcp_f32 v37, v37
    v_rcp_f32 v38, v38
    v_rcp_f32 v39, v39
    v_fma_f32 v32, v32, -2.0, 1.0
    v_fma_f32 v33, v33, -2.0, 1.0
    v_fma_f32 v34, v34, -2.0, 1.0
    v_fma_f32 v35, v35, -2.0, 1.0
    v_fma_f32 v36, v36, -2.0, 1.0
    v_fma_f32 v37, v37, -2.0, 1.0
    v_fma_f32 v38, v38, -2.0, 1.0
    v_fma_f32 v39, v39, -2.0, 1.0
    v_cvt_pk_bf16_f32 v40, v32, v33
    v_cvt_pk_bf16_f32 v41, v34, v35
    v_cvt_pk_bf16_f32 v42, v36, v37
    v_cvt_pk_bf16_f32 v43, v38, v39
    ds_write_b128 v8, v[40:43] offset:32768
    ds_read_b128 v[16:19], v7 offset:10240
    ds_read_b128 v[20:23], v7 offset:10256
    s_waitcnt lgkmcnt(3)
    s_barrier
    v_fma_f32 v32, v24, v200, 1.0
    v_fma_f32 v33, v25, v201, 1.0
    v_fma_f32 v34, v26, v202, 1.0
    v_fma_f32 v35, v27, v203, 1.0
    v_fma_f32 v36, v28, v204, 1.0
    v_fma_f32 v37, v29, v205, 1.0
    v_fma_f32 v38, v30, v206, 1.0
    v_fma_f32 v39, v31, v207, 1.0
    v_rcp_f32 v32, v32
    v_rcp_f32 v33, v33
    v_rcp_f32 v34, v34
    v_rcp_f32 v35, v35
    v_rcp_f32 v36, v36
    v_rcp_f32 v37, v37
    v_rcp_f32 v38, v38
    v_rcp_f32 v39, v39
    v_fma_f32 v32, v32, -2.0, 1.0
    v_fma_f32 v33, v33, -2.0, 1.0
    v_fma_f32 v34, v34, -2.0, 1.0
    v_fma_f32 v35, v35, -2.0, 1.0
    v_fma_f32 v36, v36, -2.0, 1.0
    v_fma_f32 v37, v37, -2.0, 1.0
    v_fma_f32 v38, v38, -2.0, 1.0
    v_fma_f32 v39, v39, -2.0, 1.0
    v_cvt_pk_bf16_f32 v44, v32, v33
    v_cvt_pk_bf16_f32 v45, v34, v35
    v_cvt_pk_bf16_f32 v46, v36, v37
    v_cvt_pk_bf16_f32 v47, v38, v39
    ds_write_b128 v8, v[44:47] offset:36864
    ds_read_b128 v[24:27], v7 offset:11264
    ds_read_b128 v[28:31], v7 offset:11280
    s_waitcnt lgkmcnt(3)
    s_barrier
    v_fma_f32 v32, v16, v208, 1.0
    v_fma_f32 v33, v17, v209, 1.0
    v_fma_f32 v34, v18, v210, 1.0
    v_fma_f32 v35, v19, v211, 1.0
    v_fma_f32 v36, v20, v212, 1.0
    v_fma_f32 v37, v21, v213, 1.0
    v_fma_f32 v38, v22, v214, 1.0
    v_fma_f32 v39, v23, v215, 1.0
    v_rcp_f32 v32, v32
    v_rcp_f32 v33, v33
    v_rcp_f32 v34, v34
    v_rcp_f32 v35, v35
    v_rcp_f32 v36, v36
    v_rcp_f32 v37, v37
    v_rcp_f32 v38, v38
    v_rcp_f32 v39, v39
    v_fma_f32 v32, v32, -2.0, 1.0
    v_fma_f32 v33, v33, -2.0, 1.0
    v_fma_f32 v34, v34, -2.0, 1.0
    v_fma_f32 v35, v35, -2.0, 1.0
    v_fma_f32 v36, v36, -2.0, 1.0
    v_fma_f32 v37, v37, -2.0, 1.0
    v_fma_f32 v38, v38, -2.0, 1.0
    v_fma_f32 v39, v39, -2.0, 1.0
    v_cvt_pk_bf16_f32 v40, v32, v33
    v_cvt_pk_bf16_f32 v41, v34, v35
    v_cvt_pk_bf16_f32 v42, v36, v37
    v_cvt_pk_bf16_f32 v43, v38, v39
    ds_write_b128 v8, v[40:43] offset:40960
    ds_read_b128 v[16:19], v7 offset:12288
    ds_read_b128 v[20:23], v7 offset:12304
    s_waitcnt lgkmcnt(3)
    s_barrier
    v_fma_f32 v32, v24, v216, 1.0
    v_fma_f32 v33, v25, v217, 1.0
    v_fma_f32 v34, v26, v218, 1.0
    v_fma_f32 v35, v27, v219, 1.0
    v_fma_f32 v36, v28, v220, 1.0
    v_fma_f32 v37, v29, v221, 1.0
    v_fma_f32 v38, v30, v222, 1.0
    v_fma_f32 v39, v31, v223, 1.0
    v_rcp_f32 v32, v32
    v_rcp_f32 v33, v33
    v_rcp_f32 v34, v34
    v_rcp_f32 v35, v35
    v_rcp_f32 v36, v36
    v_rcp_f32 v37, v37
    v_rcp_f32 v38, v38
    v_rcp_f32 v39, v39
    v_fma_f32 v32, v32, -2.0, 1.0
    v_fma_f32 v33, v33, -2.0, 1.0
    v_fma_f32 v34, v34, -2.0, 1.0
    v_fma_f32 v35, v35, -2.0, 1.0
    v_fma_f32 v36, v36, -2.0, 1.0
    v_fma_f32 v37, v37, -2.0, 1.0
    v_fma_f32 v38, v38, -2.0, 1.0
    v_fma_f32 v39, v39, -2.0, 1.0
    v_cvt_pk_bf16_f32 v44, v32, v33
    v_cvt_pk_bf16_f32 v45, v34, v35
    v_cvt_pk_bf16_f32 v46, v36, v37
    v_cvt_pk_bf16_f32 v47, v38, v39
    ds_write_b128 v8, v[44:47] offset:45056
    ds_read_b128 v[24:27], v7 offset:13312
    ds_read_b128 v[28:31], v7 offset:13328
    s_waitcnt lgkmcnt(3)
    s_barrier
    v_fma_f32 v32, v16, v224, 1.0
    v_fma_f32 v33, v17, v225, 1.0
    v_fma_f32 v34, v18, v226, 1.0
    v_fma_f32 v35, v19, v227, 1.0
    v_fma_f32 v36, v20, v228, 1.0
    v_fma_f32 v37, v21, v229, 1.0
    v_fma_f32 v38, v22, v230, 1.0
    v_fma_f32 v39, v23, v231, 1.0
    v_rcp_f32 v32, v32
    v_rcp_f32 v33, v33
    v_rcp_f32 v34, v34
    v_rcp_f32 v35, v35
    v_rcp_f32 v36, v36
    v_rcp_f32 v37, v37
    v_rcp_f32 v38, v38
    v_rcp_f32 v39, v39
    v_fma_f32 v32, v32, -2.0, 1.0
    v_fma_f32 v33, v33, -2.0, 1.0
    v_fma_f32 v34, v34, -2.0, 1.0
    v_fma_f32 v35, v35, -2.0, 1.0
    v_fma_f32 v36, v36, -2.0, 1.0
    v_fma_f32 v37, v37, -2.0, 1.0
    v_fma_f32 v38, v38, -2.0, 1.0
    v_fma_f32 v39, v39, -2.0, 1.0
    v_cvt_pk_bf16_f32 v40, v32, v33
    v_cvt_pk_bf16_f32 v41, v34, v35
    v_cvt_pk_bf16_f32 v42, v36, v37
    v_cvt_pk_bf16_f32 v43, v38, v39
    ds_write_b128 v8, v[40:43] offset:49152
    ds_read_b128 v[16:19], v7 offset:14336
    ds_read_b128 v[20:23], v7 offset:14352
    s_waitcnt lgkmcnt(3)
    s_barrier
    v_fma_f32 v32, v24, v232, 1.0
    v_fma_f32 v33, v25, v233, 1.0
    v_fma_f32 v34, v26, v234, 1.0
    v_fma_f32 v35, v27, v235, 1.0
    v_fma_f32 v36, v28, v236, 1.0
    v_fma_f32 v37, v29, v237, 1.0
    v_fma_f32 v38, v30, v238, 1.0
    v_fma_f32 v39, v31, v239, 1.0
    v_rcp_f32 v32, v32
    v_rcp_f32 v33, v33
    v_rcp_f32 v34, v34
    v_rcp_f32 v35, v35
    v_rcp_f32 v36, v36
    v_rcp_f32 v37, v37
    v_rcp_f32 v38, v38
    v_rcp_f32 v39, v39
    v_fma_f32 v32, v32, -2.0, 1.0
    v_fma_f32 v33, v33, -2.0, 1.0
    v_fma_f32 v34, v34, -2.0, 1.0
    v_fma_f32 v35, v35, -2.0, 1.0
    v_fma_f32 v36, v36, -2.0, 1.0
    v_fma_f32 v37, v37, -2.0, 1.0
    v_fma_f32 v38, v38, -2.0, 1.0
    v_fma_f32 v39, v39, -2.0, 1.0
    v_cvt_pk_bf16_f32 v44, v32, v33
    v_cvt_pk_bf16_f32 v45, v34, v35
    v_cvt_pk_bf16_f32 v46, v36, v37
    v_cvt_pk_bf16_f32 v47, v38, v39
    ds_write_b128 v8, v[44:47] offset:53248
    ds_read_b128 v[24:27], v7 offset:15360
    ds_read_b128 v[28:31], v7 offset:15376
    s_waitcnt lgkmcnt(3)
    s_barrier
    v_fma_f32 v32, v16, v240, 1.0
    v_fma_f32 v33, v17, v241, 1.0
    v_fma_f32 v34, v18, v242, 1.0
    v_fma_f32 v35, v19, v243, 1.0
    v_fma_f32 v36, v20, v244, 1.0
    v_fma_f32 v37, v21, v245, 1.0
    v_fma_f32 v38, v22, v246, 1.0
    v_fma_f32 v39, v23, v247, 1.0
    v_rcp_f32 v32, v32
    v_rcp_f32 v33, v33
    v_rcp_f32 v34, v34
    v_rcp_f32 v35, v35
    v_rcp_f32 v36, v36
    v_rcp_f32 v37, v37
    v_rcp_f32 v38, v38
    v_rcp_f32 v39, v39
    v_fma_f32 v32, v32, -2.0, 1.0
    v_fma_f32 v33, v33, -2.0, 1.0
    v_fma_f32 v34, v34, -2.0, 1.0
    v_fma_f32 v35, v35, -2.0, 1.0
    v_fma_f32 v36, v36, -2.0, 1.0
    v_fma_f32 v37, v37, -2.0, 1.0
    v_fma_f32 v38, v38, -2.0, 1.0
    v_fma_f32 v39, v39, -2.0, 1.0
    v_cvt_pk_bf16_f32 v40, v32, v33
    v_cvt_pk_bf16_f32 v41, v34, v35
    v_cvt_pk_bf16_f32 v42, v36, v37
    v_cvt_pk_bf16_f32 v43, v38, v39
    ds_write_b128 v8, v[40:43] offset:57344
    s_waitcnt lgkmcnt(1)
    s_barrier
    v_fma_f32 v32, v24, v248, 1.0
    v_fma_f32 v33, v25, v249, 1.0
    v_fma_f32 v34, v26, v250, 1.0
    v_fma_f32 v35, v27, v251, 1.0
    v_fma_f32 v36, v28, v252, 1.0
    v_fma_f32 v37, v29, v253, 1.0
    v_fma_f32 v38, v30, v254, 1.0
    v_fma_f32 v39, v31, v255, 1.0
    v_rcp_f32 v32, v32
    v_rcp_f32 v33, v33
    v_rcp_f32 v34, v34
    v_rcp_f32 v35, v35
    v_rcp_f32 v36, v36
    v_rcp_f32 v37, v37
    v_rcp_f32 v38, v38
    v_rcp_f32 v39, v39
    v_fma_f32 v32, v32, -2.0, 1.0
    v_fma_f32 v33, v33, -2.0, 1.0
    v_fma_f32 v34, v34, -2.0, 1.0
    v_fma_f32 v35, v35, -2.0, 1.0
    v_fma_f32 v36, v36, -2.0, 1.0
    v_fma_f32 v37, v37, -2.0, 1.0
    v_fma_f32 v38, v38, -2.0, 1.0
    v_fma_f32 v39, v39, -2.0, 1.0
    v_cvt_pk_bf16_f32 v44, v32, v33
    v_cvt_pk_bf16_f32 v45, v34, v35
    v_cvt_pk_bf16_f32 v46, v36, v37
    v_cvt_pk_bf16_f32 v47, v38, v39
    ds_write_b128 v8, v[44:47] offset:61440
    s_waitcnt lgkmcnt(1)
    s_barrier
    s_waitcnt lgkmcnt(0)
    s_barrier
    s_branch Lu_85
Lu_84:
    ds_read_b128 v[16:19], v7 offset:0
    ds_read_b128 v[20:23], v7 offset:16
    ds_read_b128 v[24:27], v7 offset:1024
    ds_read_b128 v[28:31], v7 offset:1040
    s_waitcnt lgkmcnt(2)
    v_add_f32 v32, v16, v128
    v_add_f32 v33, v17, v129
    v_add_f32 v34, v18, v130
    v_add_f32 v35, v19, v131
    v_add_f32 v36, v20, v132
    v_add_f32 v37, v21, v133
    v_add_f32 v38, v22, v134
    v_add_f32 v39, v23, v135
    v_exp_f32 v32, v32
    v_exp_f32 v33, v33
    v_exp_f32 v34, v34
    v_exp_f32 v35, v35
    v_exp_f32 v36, v36
    v_exp_f32 v37, v37
    v_exp_f32 v38, v38
    v_exp_f32 v39, v39
    v_add_f32 v32, 1.0, v32
    v_add_f32 v33, 1.0, v33
    v_add_f32 v34, 1.0, v34
    v_add_f32 v35, 1.0, v35
    v_add_f32 v36, 1.0, v36
    v_add_f32 v37, 1.0, v37
    v_add_f32 v38, 1.0, v38
    v_add_f32 v39, 1.0, v39
    v_rcp_f32 v32, v32
    v_rcp_f32 v33, v33
    v_rcp_f32 v34, v34
    v_rcp_f32 v35, v35
    v_rcp_f32 v36, v36
    v_rcp_f32 v37, v37
    v_rcp_f32 v38, v38
    v_rcp_f32 v39, v39
    v_fma_f32 v32, v32, -2.0, 1.0
    v_fma_f32 v33, v33, -2.0, 1.0
    v_fma_f32 v34, v34, -2.0, 1.0
    v_fma_f32 v35, v35, -2.0, 1.0
    v_fma_f32 v36, v36, -2.0, 1.0
    v_fma_f32 v37, v37, -2.0, 1.0
    v_fma_f32 v38, v38, -2.0, 1.0
    v_fma_f32 v39, v39, -2.0, 1.0
    v_cvt_pk_bf16_f32 v40, v32, v33
    v_cvt_pk_bf16_f32 v41, v34, v35
    v_cvt_pk_bf16_f32 v42, v36, v37
    v_cvt_pk_bf16_f32 v43, v38, v39
    ds_write_b128 v8, v[40:43] offset:0
    ds_read_b128 v[16:19], v7 offset:2048
    ds_read_b128 v[20:23], v7 offset:2064
    s_waitcnt lgkmcnt(3)
    v_add_f32 v32, v24, v136
    v_add_f32 v33, v25, v137
    v_add_f32 v34, v26, v138
    v_add_f32 v35, v27, v139
    v_add_f32 v36, v28, v140
    v_add_f32 v37, v29, v141
    v_add_f32 v38, v30, v142
    v_add_f32 v39, v31, v143
    v_exp_f32 v32, v32
    v_exp_f32 v33, v33
    v_exp_f32 v34, v34
    v_exp_f32 v35, v35
    v_exp_f32 v36, v36
    v_exp_f32 v37, v37
    v_exp_f32 v38, v38
    v_exp_f32 v39, v39
    v_add_f32 v32, 1.0, v32
    v_add_f32 v33, 1.0, v33
    v_add_f32 v34, 1.0, v34
    v_add_f32 v35, 1.0, v35
    v_add_f32 v36, 1.0, v36
    v_add_f32 v37, 1.0, v37
    v_add_f32 v38, 1.0, v38
    v_add_f32 v39, 1.0, v39
    v_rcp_f32 v32, v32
    v_rcp_f32 v33, v33
    v_rcp_f32 v34, v34
    v_rcp_f32 v35, v35
    v_rcp_f32 v36, v36
    v_rcp_f32 v37, v37
    v_rcp_f32 v38, v38
    v_rcp_f32 v39, v39
    v_fma_f32 v32, v32, -2.0, 1.0
    v_fma_f32 v33, v33, -2.0, 1.0
    v_fma_f32 v34, v34, -2.0, 1.0
    v_fma_f32 v35, v35, -2.0, 1.0
    v_fma_f32 v36, v36, -2.0, 1.0
    v_fma_f32 v37, v37, -2.0, 1.0
    v_fma_f32 v38, v38, -2.0, 1.0
    v_fma_f32 v39, v39, -2.0, 1.0
    v_cvt_pk_bf16_f32 v44, v32, v33
    v_cvt_pk_bf16_f32 v45, v34, v35
    v_cvt_pk_bf16_f32 v46, v36, v37
    v_cvt_pk_bf16_f32 v47, v38, v39
    ds_write_b128 v8, v[44:47] offset:4096
    s_waitcnt lgkmcnt(0)
    s_barrier
    ds_read_b128 v[24:27], v7 offset:3072
    ds_read_b128 v[28:31], v7 offset:3088
    s_waitcnt lgkmcnt(2)
    v_add_f32 v32, v16, v144
    v_add_f32 v33, v17, v145
    v_add_f32 v34, v18, v146
    v_add_f32 v35, v19, v147
    v_add_f32 v36, v20, v148
    v_add_f32 v37, v21, v149
    v_add_f32 v38, v22, v150
    v_add_f32 v39, v23, v151
    v_exp_f32 v32, v32
    v_exp_f32 v33, v33
    v_exp_f32 v34, v34
    v_exp_f32 v35, v35
    v_exp_f32 v36, v36
    v_exp_f32 v37, v37
    v_exp_f32 v38, v38
    v_exp_f32 v39, v39
    v_add_f32 v32, 1.0, v32
    v_add_f32 v33, 1.0, v33
    v_add_f32 v34, 1.0, v34
    v_add_f32 v35, 1.0, v35
    v_add_f32 v36, 1.0, v36
    v_add_f32 v37, 1.0, v37
    v_add_f32 v38, 1.0, v38
    v_add_f32 v39, 1.0, v39
    v_rcp_f32 v32, v32
    v_rcp_f32 v33, v33
    v_rcp_f32 v34, v34
    v_rcp_f32 v35, v35
    v_rcp_f32 v36, v36
    v_rcp_f32 v37, v37
    v_rcp_f32 v38, v38
    v_rcp_f32 v39, v39
    v_fma_f32 v32, v32, -2.0, 1.0
    v_fma_f32 v33, v33, -2.0, 1.0
    v_fma_f32 v34, v34, -2.0, 1.0
    v_fma_f32 v35, v35, -2.0, 1.0
    v_fma_f32 v36, v36, -2.0, 1.0
    v_fma_f32 v37, v37, -2.0, 1.0
    v_fma_f32 v38, v38, -2.0, 1.0
    v_fma_f32 v39, v39, -2.0, 1.0
    v_cvt_pk_bf16_f32 v40, v32, v33
    v_cvt_pk_bf16_f32 v41, v34, v35
    v_cvt_pk_bf16_f32 v42, v36, v37
    v_cvt_pk_bf16_f32 v43, v38, v39
    ds_write_b128 v8, v[40:43] offset:8192
    ds_read_b128 v[16:19], v7 offset:4096
    ds_read_b128 v[20:23], v7 offset:4112
    s_waitcnt lgkmcnt(3)
    v_add_f32 v32, v24, v152
    v_add_f32 v33, v25, v153
    v_add_f32 v34, v26, v154
    v_add_f32 v35, v27, v155
    v_add_f32 v36, v28, v156
    v_add_f32 v37, v29, v157
    v_add_f32 v38, v30, v158
    v_add_f32 v39, v31, v159
    v_exp_f32 v32, v32
    v_exp_f32 v33, v33
    v_exp_f32 v34, v34
    v_exp_f32 v35, v35
    v_exp_f32 v36, v36
    v_exp_f32 v37, v37
    v_exp_f32 v38, v38
    v_exp_f32 v39, v39
    v_add_f32 v32, 1.0, v32
    v_add_f32 v33, 1.0, v33
    v_add_f32 v34, 1.0, v34
    v_add_f32 v35, 1.0, v35
    v_add_f32 v36, 1.0, v36
    v_add_f32 v37, 1.0, v37
    v_add_f32 v38, 1.0, v38
    v_add_f32 v39, 1.0, v39
    v_rcp_f32 v32, v32
    v_rcp_f32 v33, v33
    v_rcp_f32 v34, v34
    v_rcp_f32 v35, v35
    v_rcp_f32 v36, v36
    v_rcp_f32 v37, v37
    v_rcp_f32 v38, v38
    v_rcp_f32 v39, v39
    v_fma_f32 v32, v32, -2.0, 1.0
    v_fma_f32 v33, v33, -2.0, 1.0
    v_fma_f32 v34, v34, -2.0, 1.0
    v_fma_f32 v35, v35, -2.0, 1.0
    v_fma_f32 v36, v36, -2.0, 1.0
    v_fma_f32 v37, v37, -2.0, 1.0
    v_fma_f32 v38, v38, -2.0, 1.0
    v_fma_f32 v39, v39, -2.0, 1.0
    v_cvt_pk_bf16_f32 v44, v32, v33
    v_cvt_pk_bf16_f32 v45, v34, v35
    v_cvt_pk_bf16_f32 v46, v36, v37
    v_cvt_pk_bf16_f32 v47, v38, v39
    ds_write_b128 v8, v[44:47] offset:12288
    ds_read_b128 v[24:27], v7 offset:5120
    ds_read_b128 v[28:31], v7 offset:5136
    s_waitcnt lgkmcnt(3)
    s_barrier
    v_add_f32 v32, v16, v160
    v_add_f32 v33, v17, v161
    v_add_f32 v34, v18, v162
    v_add_f32 v35, v19, v163
    v_add_f32 v36, v20, v164
    v_add_f32 v37, v21, v165
    v_add_f32 v38, v22, v166
    v_add_f32 v39, v23, v167
    v_exp_f32 v32, v32
    v_exp_f32 v33, v33
    v_exp_f32 v34, v34
    v_exp_f32 v35, v35
    v_exp_f32 v36, v36
    v_exp_f32 v37, v37
    v_exp_f32 v38, v38
    v_exp_f32 v39, v39
    v_add_f32 v32, 1.0, v32
    v_add_f32 v33, 1.0, v33
    v_add_f32 v34, 1.0, v34
    v_add_f32 v35, 1.0, v35
    v_add_f32 v36, 1.0, v36
    v_add_f32 v37, 1.0, v37
    v_add_f32 v38, 1.0, v38
    v_add_f32 v39, 1.0, v39
    v_rcp_f32 v32, v32
    v_rcp_f32 v33, v33
    v_rcp_f32 v34, v34
    v_rcp_f32 v35, v35
    v_rcp_f32 v36, v36
    v_rcp_f32 v37, v37
    v_rcp_f32 v38, v38
    v_rcp_f32 v39, v39
    v_fma_f32 v32, v32, -2.0, 1.0
    v_fma_f32 v33, v33, -2.0, 1.0
    v_fma_f32 v34, v34, -2.0, 1.0
    v_fma_f32 v35, v35, -2.0, 1.0
    v_fma_f32 v36, v36, -2.0, 1.0
    v_fma_f32 v37, v37, -2.0, 1.0
    v_fma_f32 v38, v38, -2.0, 1.0
    v_fma_f32 v39, v39, -2.0, 1.0
    v_cvt_pk_bf16_f32 v40, v32, v33
    v_cvt_pk_bf16_f32 v41, v34, v35
    v_cvt_pk_bf16_f32 v42, v36, v37
    v_cvt_pk_bf16_f32 v43, v38, v39
    ds_write_b128 v8, v[40:43] offset:16384
    ds_read_b128 v[16:19], v7 offset:6144
    ds_read_b128 v[20:23], v7 offset:6160
    s_waitcnt lgkmcnt(3)
    s_barrier
    v_add_f32 v32, v24, v168
    v_add_f32 v33, v25, v169
    v_add_f32 v34, v26, v170
    v_add_f32 v35, v27, v171
    v_add_f32 v36, v28, v172
    v_add_f32 v37, v29, v173
    v_add_f32 v38, v30, v174
    v_add_f32 v39, v31, v175
    v_exp_f32 v32, v32
    v_exp_f32 v33, v33
    v_exp_f32 v34, v34
    v_exp_f32 v35, v35
    v_exp_f32 v36, v36
    v_exp_f32 v37, v37
    v_exp_f32 v38, v38
    v_exp_f32 v39, v39
    v_add_f32 v32, 1.0, v32
    v_add_f32 v33, 1.0, v33
    v_add_f32 v34, 1.0, v34
    v_add_f32 v35, 1.0, v35
    v_add_f32 v36, 1.0, v36
    v_add_f32 v37, 1.0, v37
    v_add_f32 v38, 1.0, v38
    v_add_f32 v39, 1.0, v39
    v_rcp_f32 v32, v32
    v_rcp_f32 v33, v33
    v_rcp_f32 v34, v34
    v_rcp_f32 v35, v35
    v_rcp_f32 v36, v36
    v_rcp_f32 v37, v37
    v_rcp_f32 v38, v38
    v_rcp_f32 v39, v39
    v_fma_f32 v32, v32, -2.0, 1.0
    v_fma_f32 v33, v33, -2.0, 1.0
    v_fma_f32 v34, v34, -2.0, 1.0
    v_fma_f32 v35, v35, -2.0, 1.0
    v_fma_f32 v36, v36, -2.0, 1.0
    v_fma_f32 v37, v37, -2.0, 1.0
    v_fma_f32 v38, v38, -2.0, 1.0
    v_fma_f32 v39, v39, -2.0, 1.0
    v_cvt_pk_bf16_f32 v44, v32, v33
    v_cvt_pk_bf16_f32 v45, v34, v35
    v_cvt_pk_bf16_f32 v46, v36, v37
    v_cvt_pk_bf16_f32 v47, v38, v39
    ds_write_b128 v8, v[44:47] offset:20480
    ds_read_b128 v[24:27], v7 offset:7168
    ds_read_b128 v[28:31], v7 offset:7184
    s_waitcnt lgkmcnt(3)
    s_barrier
    v_add_f32 v32, v16, v176
    v_add_f32 v33, v17, v177
    v_add_f32 v34, v18, v178
    v_add_f32 v35, v19, v179
    v_add_f32 v36, v20, v180
    v_add_f32 v37, v21, v181
    v_add_f32 v38, v22, v182
    v_add_f32 v39, v23, v183
    v_exp_f32 v32, v32
    v_exp_f32 v33, v33
    v_exp_f32 v34, v34
    v_exp_f32 v35, v35
    v_exp_f32 v36, v36
    v_exp_f32 v37, v37
    v_exp_f32 v38, v38
    v_exp_f32 v39, v39
    v_add_f32 v32, 1.0, v32
    v_add_f32 v33, 1.0, v33
    v_add_f32 v34, 1.0, v34
    v_add_f32 v35, 1.0, v35
    v_add_f32 v36, 1.0, v36
    v_add_f32 v37, 1.0, v37
    v_add_f32 v38, 1.0, v38
    v_add_f32 v39, 1.0, v39
    v_rcp_f32 v32, v32
    v_rcp_f32 v33, v33
    v_rcp_f32 v34, v34
    v_rcp_f32 v35, v35
    v_rcp_f32 v36, v36
    v_rcp_f32 v37, v37
    v_rcp_f32 v38, v38
    v_rcp_f32 v39, v39
    v_fma_f32 v32, v32, -2.0, 1.0
    v_fma_f32 v33, v33, -2.0, 1.0
    v_fma_f32 v34, v34, -2.0, 1.0
    v_fma_f32 v35, v35, -2.0, 1.0
    v_fma_f32 v36, v36, -2.0, 1.0
    v_fma_f32 v37, v37, -2.0, 1.0
    v_fma_f32 v38, v38, -2.0, 1.0
    v_fma_f32 v39, v39, -2.0, 1.0
    v_cvt_pk_bf16_f32 v40, v32, v33
    v_cvt_pk_bf16_f32 v41, v34, v35
    v_cvt_pk_bf16_f32 v42, v36, v37
    v_cvt_pk_bf16_f32 v43, v38, v39
    ds_write_b128 v8, v[40:43] offset:24576
    ds_read_b128 v[16:19], v7 offset:8192
    ds_read_b128 v[20:23], v7 offset:8208
    s_waitcnt lgkmcnt(3)
    s_barrier
    v_add_f32 v32, v24, v184
    v_add_f32 v33, v25, v185
    v_add_f32 v34, v26, v186
    v_add_f32 v35, v27, v187
    v_add_f32 v36, v28, v188
    v_add_f32 v37, v29, v189
    v_add_f32 v38, v30, v190
    v_add_f32 v39, v31, v191
    v_exp_f32 v32, v32
    v_exp_f32 v33, v33
    v_exp_f32 v34, v34
    v_exp_f32 v35, v35
    v_exp_f32 v36, v36
    v_exp_f32 v37, v37
    v_exp_f32 v38, v38
    v_exp_f32 v39, v39
    v_add_f32 v32, 1.0, v32
    v_add_f32 v33, 1.0, v33
    v_add_f32 v34, 1.0, v34
    v_add_f32 v35, 1.0, v35
    v_add_f32 v36, 1.0, v36
    v_add_f32 v37, 1.0, v37
    v_add_f32 v38, 1.0, v38
    v_add_f32 v39, 1.0, v39
    v_rcp_f32 v32, v32
    v_rcp_f32 v33, v33
    v_rcp_f32 v34, v34
    v_rcp_f32 v35, v35
    v_rcp_f32 v36, v36
    v_rcp_f32 v37, v37
    v_rcp_f32 v38, v38
    v_rcp_f32 v39, v39
    v_fma_f32 v32, v32, -2.0, 1.0
    v_fma_f32 v33, v33, -2.0, 1.0
    v_fma_f32 v34, v34, -2.0, 1.0
    v_fma_f32 v35, v35, -2.0, 1.0
    v_fma_f32 v36, v36, -2.0, 1.0
    v_fma_f32 v37, v37, -2.0, 1.0
    v_fma_f32 v38, v38, -2.0, 1.0
    v_fma_f32 v39, v39, -2.0, 1.0
    v_cvt_pk_bf16_f32 v44, v32, v33
    v_cvt_pk_bf16_f32 v45, v34, v35
    v_cvt_pk_bf16_f32 v46, v36, v37
    v_cvt_pk_bf16_f32 v47, v38, v39
    ds_write_b128 v8, v[44:47] offset:28672
    ds_read_b128 v[24:27], v7 offset:9216
    ds_read_b128 v[28:31], v7 offset:9232
    s_waitcnt lgkmcnt(3)
    s_barrier
    v_add_f32 v32, v16, v192
    v_add_f32 v33, v17, v193
    v_add_f32 v34, v18, v194
    v_add_f32 v35, v19, v195
    v_add_f32 v36, v20, v196
    v_add_f32 v37, v21, v197
    v_add_f32 v38, v22, v198
    v_add_f32 v39, v23, v199
    v_exp_f32 v32, v32
    v_exp_f32 v33, v33
    v_exp_f32 v34, v34
    v_exp_f32 v35, v35
    v_exp_f32 v36, v36
    v_exp_f32 v37, v37
    v_exp_f32 v38, v38
    v_exp_f32 v39, v39
    v_add_f32 v32, 1.0, v32
    v_add_f32 v33, 1.0, v33
    v_add_f32 v34, 1.0, v34
    v_add_f32 v35, 1.0, v35
    v_add_f32 v36, 1.0, v36
    v_add_f32 v37, 1.0, v37
    v_add_f32 v38, 1.0, v38
    v_add_f32 v39, 1.0, v39
    v_rcp_f32 v32, v32
    v_rcp_f32 v33, v33
    v_rcp_f32 v34, v34
    v_rcp_f32 v35, v35
    v_rcp_f32 v36, v36
    v_rcp_f32 v37, v37
    v_rcp_f32 v38, v38
    v_rcp_f32 v39, v39
    v_fma_f32 v32, v32, -2.0, 1.0
    v_fma_f32 v33, v33, -2.0, 1.0
    v_fma_f32 v34, v34, -2.0, 1.0
    v_fma_f32 v35, v35, -2.0, 1.0
    v_fma_f32 v36, v36, -2.0, 1.0
    v_fma_f32 v37, v37, -2.0, 1.0
    v_fma_f32 v38, v38, -2.0, 1.0
    v_fma_f32 v39, v39, -2.0, 1.0
    v_cvt_pk_bf16_f32 v40, v32, v33
    v_cvt_pk_bf16_f32 v41, v34, v35
    v_cvt_pk_bf16_f32 v42, v36, v37
    v_cvt_pk_bf16_f32 v43, v38, v39
    ds_write_b128 v8, v[40:43] offset:32768
    ds_read_b128 v[16:19], v7 offset:10240
    ds_read_b128 v[20:23], v7 offset:10256
    s_waitcnt lgkmcnt(3)
    s_barrier
    v_add_f32 v32, v24, v200
    v_add_f32 v33, v25, v201
    v_add_f32 v34, v26, v202
    v_add_f32 v35, v27, v203
    v_add_f32 v36, v28, v204
    v_add_f32 v37, v29, v205
    v_add_f32 v38, v30, v206
    v_add_f32 v39, v31, v207
    v_exp_f32 v32, v32
    v_exp_f32 v33, v33
    v_exp_f32 v34, v34
    v_exp_f32 v35, v35
    v_exp_f32 v36, v36
    v_exp_f32 v37, v37
    v_exp_f32 v38, v38
    v_exp_f32 v39, v39
    v_add_f32 v32, 1.0, v32
    v_add_f32 v33, 1.0, v33
    v_add_f32 v34, 1.0, v34
    v_add_f32 v35, 1.0, v35
    v_add_f32 v36, 1.0, v36
    v_add_f32 v37, 1.0, v37
    v_add_f32 v38, 1.0, v38
    v_add_f32 v39, 1.0, v39
    v_rcp_f32 v32, v32
    v_rcp_f32 v33, v33
    v_rcp_f32 v34, v34
    v_rcp_f32 v35, v35
    v_rcp_f32 v36, v36
    v_rcp_f32 v37, v37
    v_rcp_f32 v38, v38
    v_rcp_f32 v39, v39
    v_fma_f32 v32, v32, -2.0, 1.0
    v_fma_f32 v33, v33, -2.0, 1.0
    v_fma_f32 v34, v34, -2.0, 1.0
    v_fma_f32 v35, v35, -2.0, 1.0
    v_fma_f32 v36, v36, -2.0, 1.0
    v_fma_f32 v37, v37, -2.0, 1.0
    v_fma_f32 v38, v38, -2.0, 1.0
    v_fma_f32 v39, v39, -2.0, 1.0
    v_cvt_pk_bf16_f32 v44, v32, v33
    v_cvt_pk_bf16_f32 v45, v34, v35
    v_cvt_pk_bf16_f32 v46, v36, v37
    v_cvt_pk_bf16_f32 v47, v38, v39
    ds_write_b128 v8, v[44:47] offset:36864
    ds_read_b128 v[24:27], v7 offset:11264
    ds_read_b128 v[28:31], v7 offset:11280
    s_waitcnt lgkmcnt(3)
    s_barrier
    v_add_f32 v32, v16, v208
    v_add_f32 v33, v17, v209
    v_add_f32 v34, v18, v210
    v_add_f32 v35, v19, v211
    v_add_f32 v36, v20, v212
    v_add_f32 v37, v21, v213
    v_add_f32 v38, v22, v214
    v_add_f32 v39, v23, v215
    v_exp_f32 v32, v32
    v_exp_f32 v33, v33
    v_exp_f32 v34, v34
    v_exp_f32 v35, v35
    v_exp_f32 v36, v36
    v_exp_f32 v37, v37
    v_exp_f32 v38, v38
    v_exp_f32 v39, v39
    v_add_f32 v32, 1.0, v32
    v_add_f32 v33, 1.0, v33
    v_add_f32 v34, 1.0, v34
    v_add_f32 v35, 1.0, v35
    v_add_f32 v36, 1.0, v36
    v_add_f32 v37, 1.0, v37
    v_add_f32 v38, 1.0, v38
    v_add_f32 v39, 1.0, v39
    v_rcp_f32 v32, v32
    v_rcp_f32 v33, v33
    v_rcp_f32 v34, v34
    v_rcp_f32 v35, v35
    v_rcp_f32 v36, v36
    v_rcp_f32 v37, v37
    v_rcp_f32 v38, v38
    v_rcp_f32 v39, v39
    v_fma_f32 v32, v32, -2.0, 1.0
    v_fma_f32 v33, v33, -2.0, 1.0
    v_fma_f32 v34, v34, -2.0, 1.0
    v_fma_f32 v35, v35, -2.0, 1.0
    v_fma_f32 v36, v36, -2.0, 1.0
    v_fma_f32 v37, v37, -2.0, 1.0
    v_fma_f32 v38, v38, -2.0, 1.0
    v_fma_f32 v39, v39, -2.0, 1.0
    v_cvt_pk_bf16_f32 v40, v32, v33
    v_cvt_pk_bf16_f32 v41, v34, v35
    v_cvt_pk_bf16_f32 v42, v36, v37
    v_cvt_pk_bf16_f32 v43, v38, v39
    ds_write_b128 v8, v[40:43] offset:40960
    ds_read_b128 v[16:19], v7 offset:12288
    ds_read_b128 v[20:23], v7 offset:12304
    s_waitcnt lgkmcnt(3)
    s_barrier
    v_add_f32 v32, v24, v216
    v_add_f32 v33, v25, v217
    v_add_f32 v34, v26, v218
    v_add_f32 v35, v27, v219
    v_add_f32 v36, v28, v220
    v_add_f32 v37, v29, v221
    v_add_f32 v38, v30, v222
    v_add_f32 v39, v31, v223
    v_exp_f32 v32, v32
    v_exp_f32 v33, v33
    v_exp_f32 v34, v34
    v_exp_f32 v35, v35
    v_exp_f32 v36, v36
    v_exp_f32 v37, v37
    v_exp_f32 v38, v38
    v_exp_f32 v39, v39
    v_add_f32 v32, 1.0, v32
    v_add_f32 v33, 1.0, v33
    v_add_f32 v34, 1.0, v34
    v_add_f32 v35, 1.0, v35
    v_add_f32 v36, 1.0, v36
    v_add_f32 v37, 1.0, v37
    v_add_f32 v38, 1.0, v38
    v_add_f32 v39, 1.0, v39
    v_rcp_f32 v32, v32
    v_rcp_f32 v33, v33
    v_rcp_f32 v34, v34
    v_rcp_f32 v35, v35
    v_rcp_f32 v36, v36
    v_rcp_f32 v37, v37
    v_rcp_f32 v38, v38
    v_rcp_f32 v39, v39
    v_fma_f32 v32, v32, -2.0, 1.0
    v_fma_f32 v33, v33, -2.0, 1.0
    v_fma_f32 v34, v34, -2.0, 1.0
    v_fma_f32 v35, v35, -2.0, 1.0
    v_fma_f32 v36, v36, -2.0, 1.0
    v_fma_f32 v37, v37, -2.0, 1.0
    v_fma_f32 v38, v38, -2.0, 1.0
    v_fma_f32 v39, v39, -2.0, 1.0
    v_cvt_pk_bf16_f32 v44, v32, v33
    v_cvt_pk_bf16_f32 v45, v34, v35
    v_cvt_pk_bf16_f32 v46, v36, v37
    v_cvt_pk_bf16_f32 v47, v38, v39
    ds_write_b128 v8, v[44:47] offset:45056
    ds_read_b128 v[24:27], v7 offset:13312
    ds_read_b128 v[28:31], v7 offset:13328
    s_waitcnt lgkmcnt(3)
    s_barrier
    v_add_f32 v32, v16, v224
    v_add_f32 v33, v17, v225
    v_add_f32 v34, v18, v226
    v_add_f32 v35, v19, v227
    v_add_f32 v36, v20, v228
    v_add_f32 v37, v21, v229
    v_add_f32 v38, v22, v230
    v_add_f32 v39, v23, v231
    v_exp_f32 v32, v32
    v_exp_f32 v33, v33
    v_exp_f32 v34, v34
    v_exp_f32 v35, v35
    v_exp_f32 v36, v36
    v_exp_f32 v37, v37
    v_exp_f32 v38, v38
    v_exp_f32 v39, v39
    v_add_f32 v32, 1.0, v32
    v_add_f32 v33, 1.0, v33
    v_add_f32 v34, 1.0, v34
    v_add_f32 v35, 1.0, v35
    v_add_f32 v36, 1.0, v36
    v_add_f32 v37, 1.0, v37
    v_add_f32 v38, 1.0, v38
    v_add_f32 v39, 1.0, v39
    v_rcp_f32 v32, v32
    v_rcp_f32 v33, v33
    v_rcp_f32 v34, v34
    v_rcp_f32 v35, v35
    v_rcp_f32 v36, v36
    v_rcp_f32 v37, v37
    v_rcp_f32 v38, v38
    v_rcp_f32 v39, v39
    v_fma_f32 v32, v32, -2.0, 1.0
    v_fma_f32 v33, v33, -2.0, 1.0
    v_fma_f32 v34, v34, -2.0, 1.0
    v_fma_f32 v35, v35, -2.0, 1.0
    v_fma_f32 v36, v36, -2.0, 1.0
    v_fma_f32 v37, v37, -2.0, 1.0
    v_fma_f32 v38, v38, -2.0, 1.0
    v_fma_f32 v39, v39, -2.0, 1.0
    v_cvt_pk_bf16_f32 v40, v32, v33
    v_cvt_pk_bf16_f32 v41, v34, v35
    v_cvt_pk_bf16_f32 v42, v36, v37
    v_cvt_pk_bf16_f32 v43, v38, v39
    ds_write_b128 v8, v[40:43] offset:49152
    ds_read_b128 v[16:19], v7 offset:14336
    ds_read_b128 v[20:23], v7 offset:14352
    s_waitcnt lgkmcnt(3)
    s_barrier
    v_add_f32 v32, v24, v232
    v_add_f32 v33, v25, v233
    v_add_f32 v34, v26, v234
    v_add_f32 v35, v27, v235
    v_add_f32 v36, v28, v236
    v_add_f32 v37, v29, v237
    v_add_f32 v38, v30, v238
    v_add_f32 v39, v31, v239
    v_exp_f32 v32, v32
    v_exp_f32 v33, v33
    v_exp_f32 v34, v34
    v_exp_f32 v35, v35
    v_exp_f32 v36, v36
    v_exp_f32 v37, v37
    v_exp_f32 v38, v38
    v_exp_f32 v39, v39
    v_add_f32 v32, 1.0, v32
    v_add_f32 v33, 1.0, v33
    v_add_f32 v34, 1.0, v34
    v_add_f32 v35, 1.0, v35
    v_add_f32 v36, 1.0, v36
    v_add_f32 v37, 1.0, v37
    v_add_f32 v38, 1.0, v38
    v_add_f32 v39, 1.0, v39
    v_rcp_f32 v32, v32
    v_rcp_f32 v33, v33
    v_rcp_f32 v34, v34
    v_rcp_f32 v35, v35
    v_rcp_f32 v36, v36
    v_rcp_f32 v37, v37
    v_rcp_f32 v38, v38
    v_rcp_f32 v39, v39
    v_fma_f32 v32, v32, -2.0, 1.0
    v_fma_f32 v33, v33, -2.0, 1.0
    v_fma_f32 v34, v34, -2.0, 1.0
    v_fma_f32 v35, v35, -2.0, 1.0
    v_fma_f32 v36, v36, -2.0, 1.0
    v_fma_f32 v37, v37, -2.0, 1.0
    v_fma_f32 v38, v38, -2.0, 1.0
    v_fma_f32 v39, v39, -2.0, 1.0
    v_cvt_pk_bf16_f32 v44, v32, v33
    v_cvt_pk_bf16_f32 v45, v34, v35
    v_cvt_pk_bf16_f32 v46, v36, v37
    v_cvt_pk_bf16_f32 v47, v38, v39
    ds_write_b128 v8, v[44:47] offset:53248
    ds_read_b128 v[24:27], v7 offset:15360
    ds_read_b128 v[28:31], v7 offset:15376
    s_waitcnt lgkmcnt(3)
    s_barrier
    v_add_f32 v32, v16, v240
    v_add_f32 v33, v17, v241
    v_add_f32 v34, v18, v242
    v_add_f32 v35, v19, v243
    v_add_f32 v36, v20, v244
    v_add_f32 v37, v21, v245
    v_add_f32 v38, v22, v246
    v_add_f32 v39, v23, v247
    v_exp_f32 v32, v32
    v_exp_f32 v33, v33
    v_exp_f32 v34, v34
    v_exp_f32 v35, v35
    v_exp_f32 v36, v36
    v_exp_f32 v37, v37
    v_exp_f32 v38, v38
    v_exp_f32 v39, v39
    v_add_f32 v32, 1.0, v32
    v_add_f32 v33, 1.0, v33
    v_add_f32 v34, 1.0, v34
    v_add_f32 v35, 1.0, v35
    v_add_f32 v36, 1.0, v36
    v_add_f32 v37, 1.0, v37
    v_add_f32 v38, 1.0, v38
    v_add_f32 v39, 1.0, v39
    v_rcp_f32 v32, v32
    v_rcp_f32 v33, v33
    v_rcp_f32 v34, v34
    v_rcp_f32 v35, v35
    v_rcp_f32 v36, v36
    v_rcp_f32 v37, v37
    v_rcp_f32 v38, v38
    v_rcp_f32 v39, v39
    v_fma_f32 v32, v32, -2.0, 1.0
    v_fma_f32 v33, v33, -2.0, 1.0
    v_fma_f32 v34, v34, -2.0, 1.0
    v_fma_f32 v35, v35, -2.0, 1.0
    v_fma_f32 v36, v36, -2.0, 1.0
    v_fma_f32 v37, v37, -2.0, 1.0
    v_fma_f32 v38, v38, -2.0, 1.0
    v_fma_f32 v39, v39, -2.0, 1.0
    v_cvt_pk_bf16_f32 v40, v32, v33
    v_cvt_pk_bf16_f32 v41, v34, v35
    v_cvt_pk_bf16_f32 v42, v36, v37
    v_cvt_pk_bf16_f32 v43, v38, v39
    ds_write_b128 v8, v[40:43] offset:57344
    s_waitcnt lgkmcnt(1)
    s_barrier
    v_add_f32 v32, v24, v248
    v_add_f32 v33, v25, v249
    v_add_f32 v34, v26, v250
    v_add_f32 v35, v27, v251
    v_add_f32 v36, v28, v252
    v_add_f32 v37, v29, v253
    v_add_f32 v38, v30, v254
    v_add_f32 v39, v31, v255
    v_exp_f32 v32, v32
    v_exp_f32 v33, v33
    v_exp_f32 v34, v34
    v_exp_f32 v35, v35
    v_exp_f32 v36, v36
    v_exp_f32 v37, v37
    v_exp_f32 v38, v38
    v_exp_f32 v39, v39
    v_add_f32 v32, 1.0, v32
    v_add_f32 v33, 1.0, v33
    v_add_f32 v34, 1.0, v34
    v_add_f32 v35, 1.0, v35
    v_add_f32 v36, 1.0, v36
    v_add_f32 v37, 1.0, v37
    v_add_f32 v38, 1.0, v38
    v_add_f32 v39, 1.0, v39
    v_rcp_f32 v32, v32
    v_rcp_f32 v33, v33
    v_rcp_f32 v34, v34
    v_rcp_f32 v35, v35
    v_rcp_f32 v36, v36
    v_rcp_f32 v37, v37
    v_rcp_f32 v38, v38
    v_rcp_f32 v39, v39
    v_fma_f32 v32, v32, -2.0, 1.0
    v_fma_f32 v33, v33, -2.0, 1.0
    v_fma_f32 v34, v34, -2.0, 1.0
    v_fma_f32 v35, v35, -2.0, 1.0
    v_fma_f32 v36, v36, -2.0, 1.0
    v_fma_f32 v37, v37, -2.0, 1.0
    v_fma_f32 v38, v38, -2.0, 1.0
    v_fma_f32 v39, v39, -2.0, 1.0
    v_cvt_pk_bf16_f32 v44, v32, v33
    v_cvt_pk_bf16_f32 v45, v34, v35
    v_cvt_pk_bf16_f32 v46, v36, v37
    v_cvt_pk_bf16_f32 v47, v38, v39
    ds_write_b128 v8, v[44:47] offset:61440
    s_waitcnt lgkmcnt(1)
    s_barrier
    s_waitcnt lgkmcnt(0)
    s_barrier
Lu_85:
    v_lshlrev_b32 v48, 3, v0
    v_add_u32 v48, 15929344, v48
    v_lshlrev_b32 v49, 3, v0
    v_add_u32 v49, 15929856, v49
    v_lshlrev_b32 v50, 3, v0
    v_add_u32 v50, 15930368, v50
    v_lshlrev_b32 v51, 3, v0
    v_add_u32 v51, 15930880, v51
    s_cmp_eq_u32 s2, 0
    s_cselect_b32 s56, s55, 0
    s_cmp_eq_u32 s56, 2
    s_cbranch_scc0 Lo_86
    buffer_load_dwordx2 v[52:53], v48, s[16:19], 0 offen sc1
    buffer_load_dwordx2 v[54:55], v49, s[16:19], 0 offen sc1
    buffer_load_dwordx2 v[56:57], v50, s[16:19], 0 offen sc1
    buffer_load_dwordx2 v[58:59], v51, s[16:19], 0 offen sc1
Lo_86:
    v_lshrrev_b32 v2, 5, v0
    v_and_b32 v3, 31, v0
    s_lshl_b32 s56, s55, 13
    s_add_u32 s56, s56, 98304
    v_lshl_add_u32 v4, v0, 4, s56
    v_lshrrev_b32 v5, 3, v3
    v_lshlrev_b32 v5, 8, v5
    v_and_b32 v6, 7, v3
    v_lshl_add_u32 v5, v6, 4, v5
    v_lshl_add_u32 v5, v2, 10, v5
    s_mul_i32 s56, s50, 1000
    s_mul_i32 s57, s51, 250
    s_add_u32 s56, s56, s57
    s_lshl_b32 s57, s49, 3
    s_add_u32 s56, s56, s57
    s_lshl_b32 s56, s56, 13
    s_lshl_b32 s58, s55, 14
    s_add_u32 s56, s56, s58
    s_add_u32 s56, s56, 0
    s_sub_u32 s59, 250, s57
    s_lshl_b32 s59, s59, 3
    s_lshl_b32 s58, s55, 4
    s_cmp_gt_u32 s59, s58
    s_cselect_b32 s58, 0, 0x80000000
    v_add_u32 v5, s56, v5
    v_or_b32 v5, s58, v5
    s_barrier
    ds_read_b128 v[16:19], v4 offset:0
    ds_read_b128 v[20:23], v4 offset:1024
    ds_read_b128 v[24:27], v4 offset:2048
    ds_read_b128 v[28:31], v4 offset:3072
    ds_read_b128 v[32:35], v4 offset:4096
    ds_read_b128 v[36:39], v4 offset:5120
    ds_read_b128 v[40:43], v4 offset:6144
    ds_read_b128 v[44:47], v4 offset:7168
    s_waitcnt lgkmcnt(7)
    s_mov_b32 s56, 0
    buffer_store_dwordx4 v[16:19], v5, s[20:23], s56 offen nt
    s_waitcnt lgkmcnt(6)
    s_mov_b32 s56, 2048
    buffer_store_dwordx4 v[20:23], v5, s[20:23], s56 offen nt
    s_waitcnt lgkmcnt(5)
    s_mov_b32 s56, 4096
    buffer_store_dwordx4 v[24:27], v5, s[20:23], s56 offen nt
    s_waitcnt lgkmcnt(4)
    s_mov_b32 s56, 6144
    buffer_store_dwordx4 v[28:31], v5, s[20:23], s56 offen nt
    s_waitcnt lgkmcnt(3)
    s_waitcnt vmcnt(3)
    s_mov_b32 s56, 8192
    buffer_store_dwordx4 v[32:35], v5, s[20:23], s56 offen nt
    s_waitcnt lgkmcnt(2)
    s_waitcnt vmcnt(3)
    s_mov_b32 s56, 10240
    buffer_store_dwordx4 v[36:39], v5, s[20:23], s56 offen nt
    s_waitcnt lgkmcnt(1)
    s_waitcnt vmcnt(3)
    s_mov_b32 s56, 12288
    buffer_store_dwordx4 v[40:43], v5, s[20:23], s56 offen nt
    s_waitcnt lgkmcnt(0)
    s_waitcnt vmcnt(3)
    s_mov_b32 s56, 14336
    buffer_store_dwordx4 v[44:47], v5, s[20:23], s56 offen nt
    s_cmp_eq_u32 s2, 0
    s_cselect_b32 s56, s55, 0
    s_cmp_eq_u32 s56, 2
    s_cbranch_scc0 Lo_87
    s_waitcnt vmcnt(8)
    v_cmp_ne_u32 vcc, s86, v52
    s_cbranch_vccz Lc_88
    s_mov_b32 s72, 0
Lp_89:
    buffer_load_dwordx2 v[52:53], v48, s[16:19], 0 offen sc1
    s_add_u32 s72, s72, 1
    s_cmp_ge_u32 s72, 40000
    s_cbranch_scc1 Lp_90
    s_waitcnt vmcnt(0)
    v_cmp_ne_u32 vcc, s86, v52
    s_cbranch_vccnz Lp_89
Lp_90:
    s_waitcnt vmcnt(0)
Lc_88:
    v_cmp_ne_u32 vcc, s86, v54
    s_cbranch_vccz Lc_91
    s_mov_b32 s72, 0
Lp_92:
    buffer_load_dwordx2 v[54:55], v49, s[16:19], 0 offen sc1
    s_add_u32 s72, s72, 1
    s_cmp_ge_u32 s72, 40000
    s_cbranch_scc1 Lp_93
    s_waitcnt vmcnt(0)
    v_cmp_ne_u32 vcc, s86, v54
    s_cbranch_vccnz Lp_92
Lp_93:
    s_waitcnt vmcnt(0)
Lc_91:
    v_cmp_ne_u32 vcc, s86, v56
    s_cbranch_vccz Lc_94
    s_mov_b32 s72, 0
Lp_95:
    buffer_load_dwordx2 v[56:57], v50, s[16:19], 0 offen sc1
    s_add_u32 s72, s72, 1
    s_cmp_ge_u32 s72, 40000
    s_cbranch_scc1 Lp_96
    s_waitcnt vmcnt(0)
    v_cmp_ne_u32 vcc, s86, v56
    s_cbranch_vccnz Lp_95
Lp_96:
    s_waitcnt vmcnt(0)
Lc_94:
    v_cmp_ne_u32 vcc, s86, v58
    s_cbranch_vccz Lc_97
    s_mov_b32 s72, 0
Lp_98:
    buffer_load_dwordx2 v[58:59], v51, s[16:19], 0 offen sc1
    s_add_u32 s72, s72, 1
    s_cmp_ge_u32 s72, 40000
    s_cbranch_scc1 Lp_99
    s_waitcnt vmcnt(0)
    v_cmp_ne_u32 vcc, s86, v58
    s_cbranch_vccnz Lp_98
Lp_99:
    s_waitcnt vmcnt(0)
Lc_97:
    s_mov_b32 s64, 15925248
    v_mov_b32 v2, s86
    v_mov_b32 v3, s64
    s_mov_b64 s[70:71], exec
    s_mov_b64 exec, 1
    buffer_store_dword v2, v3, s[16:19], 0 offen sc1
    s_mov_b64 exec, s[70:71]
Lo_87:
    v_lshrrev_b32 v2, 5, v0
    v_and_b32 v3, 31, v0
    s_lshl_b32 s56, s54, 12
    s_add_u32 s56, s56, 131072
    v_lshl_add_u32 v4, v0, 4, s56
    v_lshrrev_b32 v5, 3, v3
    v_lshlrev_b32 v5, 8, v5
    v_and_b32 v6, 7, v3
    v_lshl_add_u32 v5, v6, 4, v5
    v_lshl_add_u32 v5, v2, 10, v5
    s_mul_i32 s56, s50, 1000
    s_mul_i32 s57, s51, 250
    s_add_u32 s56, s56, s57
    s_lshl_b32 s57, s49, 3
    s_add_u32 s56, s56, s57
    s_lshl_b32 s56, s56, 13
    s_lshl_b32 s58, s54, 13
    s_add_u32 s56, s56, s58
    s_add_u32 s56, s56, 128
    s_sub_u32 s59, 250, s57
    s_lshl_b32 s59, s59, 3
    s_lshl_b32 s58, s54, 3
    s_cmp_gt_u32 s59, s58
    s_cselect_b32 s58, 0, 0x80000000
    v_add_u32 v5, s56, v5
    v_or_b32 v5, s58, v5
    s_barrier
    ds_read_b128 v[16:19], v4 offset:0
    ds_read_b128 v[20:23], v4 offset:1024
    ds_read_b128 v[24:27], v4 offset:2048
    ds_read_b128 v[28:31], v4 offset:3072
    s_waitcnt lgkmcnt(3)
    s_mov_b32 s56, 0
    buffer_store_dwordx4 v[16:19], v5, s[20:23], s56 offen nt
    s_waitcnt lgkmcnt(2)
    s_mov_b32 s56, 2048
    buffer_store_dwordx4 v[20:23], v5, s[20:23], s56 offen nt
    s_waitcnt lgkmcnt(1)
    s_mov_b32 s56, 4096
    buffer_store_dwordx4 v[24:27], v5, s[20:23], s56 offen nt
    s_waitcnt lgkmcnt(0)
    s_mov_b32 s56, 6144
    buffer_store_dwordx4 v[28:31], v5, s[20:23], s56 offen nt
L_fin:
    s_waitcnt vmcnt(0)
L_end:
    s_endpgm
L_code_end:
.section .rodata,"a"
.p2align 6
.amdhsa_kernel standalone__seq2seq_rnn_t_joint__speech_kernel
  .amdhsa_next_free_vgpr 256
  .amdhsa_next_free_sgpr 102
  .amdhsa_accum_offset 256
  .amdhsa_group_segment_fixed_size 0
  .amdhsa_kernarg_size 80
  .amdhsa_user_sgpr_count 2
  .amdhsa_user_sgpr_kernarg_segment_ptr 1
  .amdhsa_system_sgpr_workgroup_id_x 1
.end_amdhsa_kernel
```
